```python
import torch

def _softmax(x, axis=-1):
    return torch.softmax(x, dim=axis)
def _gelu(x):
    return torch.nn.functional.gelu(x, approximate="tanh")
def _silu(x):
    return torch.nn.functional.silu(x)
def _sigmoid(x):
    return torch.sigmoid(x)
def _layernorm(x, axis=-1, eps=1e-5):
    m = x.mean(dim=axis, keepdim=True)
    v = x.var(dim=axis, keepdim=True, unbiased=False)
    return (x - m) / torch.sqrt(v + eps)
def _scatter_add(tgt, idx, src, axis=0):
    return tgt.clone().index_add_(axis, idx, src)
def _segment_sum(src, seg, n):
    out = torch.zeros((n,) + src.shape[1:], dtype=src.dtype)
    return out.index_add_(0, seg, src)
def _pad(x, pw):
    flat = tuple(v for pair in reversed(pw) for v in pair)
    return torch.nn.functional.pad(x, flat)

kernel_name = 'standalone__swiglu_ffn__sampling'

def setup_inputs():

    _w = (lambda a: (lambda t: t.to(torch.bfloat16) if t.is_floating_point() else t)(torch.as_tensor(a)))
    B, S, D, F = 32, 32, 512, 1792
    return {
        "x": _w((lambda *s: torch.randn(*s, dtype=torch.bfloat16) * 0.05)(B, S, D)),
        "w_gate": _w((lambda *s: torch.randn(*s, dtype=torch.bfloat16) * 0.05)(D, F)),
        "w_up": _w((lambda *s: torch.randn(*s, dtype=torch.bfloat16) * 0.05)(D, F)),
        "w_down": _w((lambda *s: torch.randn(*s, dtype=torch.bfloat16) * 0.05)(F, D)),
    }

def reference(x, w_gate, w_up, w_down):
    g = _silu(x @ w_gate)
    u = x @ w_up
    return (g * u) @ w_down
```

```asm
; @launch grid=(256,1,1) block=(512,1,1) lds=163840
.amdgcn_target "amdgcn-amd-amdhsa--gfx950"
.text
.globl standalone__swiglu_ffn__sampling_kernel
.p2align 8
.type standalone__swiglu_ffn__sampling_kernel,@function
standalone__swiglu_ffn__sampling_kernel:
    s_cmp_ge_u32 s2, 256
    s_cbranch_scc1 L_end
    s_load_dwordx8 s[4:11], s[0:1], 0
    s_load_dwordx2 s[12:13], s[0:1], 32
    s_load_dwordx2 s[16:17], s[0:1], 48
    v_lshrrev_b32 v1, 6, v0
    v_and_b32 v0, 63, v0
    v_readfirstlane_b32 s3, v1
    s_and_b32 s44, s2, 7
    s_lshr_b32 s45, s2, 3
    s_and_b32 s46, s44, 1
    s_lshl_b32 s46, s46, 2
    s_and_b32 s47, s45, 3
    s_add_u32 s51, s47, s46
    s_add_u32 s14, s47, s46
    s_lshr_b32 s48, s44, 1
    s_mul_i32 s49, s48, 7
    s_lshr_b32 s50, s45, 2
    s_add_u32 s61, s50, s47
    s_add_u32 s49, s49, s50
    s_lshr_b32 s48, s44, 1
    s_lshl_b32 s48, s48, 3
    s_add_u32 s50, s50, s48
    v_lshrrev_b32 v1, 3, v0
    v_and_b32 v2, 7, v0
    v_lshrrev_b32 v3, 4, v0
    s_cmp_ge_u32 s3, 4
    s_cbranch_scc1 L_compute
    v_xor_b32 v16, v3, v2
    v_lshlrev_b32 v16, 4, v16
    v_lshl_add_u32 v4, v1, 10, v16
    v_xor_b32 v5, 64, v4
    v_add_u32 v6, 14336, v4
    v_add_u32 v7, 21504, v5
    v_add_u32 v5, 7168, v5
    v_and_b32 v16, 1, v3
    v_lshlrev_b32 v16, 1, v16
    v_xor_b32 v16, v16, v2
    v_lshlrev_b32 v16, 4, v16
    v_xor_b32 v18, 64, v16
    v_mul_u32_u24 v17, 3584, v1
    v_add_u32 v8, v17, v16
    v_add_u32 v9, v17, v18
    v_add_u32 v9, 27648, v9
    s_lshl_b32 s52, s14, 17
    s_lshl_b32 s53, s3, 15
    s_add_u32 s52, s52, s53
    s_lshl_b32 s53, s49, 7
    s_mul_i32 s54, s3, 57344
    s_add_u32 s53, s53, s54
    s_lshl_b32 s54, s3, 12
    s_mov_b32 s22, 0x100000
    s_mov_b32 s23, 0x20000
    s_mov_b32 s26, 0x1c0000
    s_mov_b32 s27, 0x20000
    s_mov_b32 s30, 1837056
    s_mov_b32 s31, 0x20000
    s_waitcnt lgkmcnt(0)
    s_mov_b32 s20, s4
    s_and_b32 s21, s5, 0xffff
    s_mov_b32 s24, s6
    s_and_b32 s25, s7, 0xffff
    s_sub_u32 s28, s8, 2048
    s_subb_u32 s29, s9, 0
    s_and_b32 s29, s29, 0xffff
    s_cmp_ge_u32 s45, 28
    s_cbranch_scc1 L_load_nop1
    s_add_u32 s57, s61, 0
    s_and_b32 s57, s57, 3
    s_lshl_b32 s63, s57, 7
    s_add_u32 s63, s63, s52
    s_mul_i32 s57, s57, 229376
    s_add_u32 m0, s54, 0
    s_add_u32 s57, s57, s53
    buffer_load_dwordx4 v4, s[20:23], s63 offen offset:0 lds
    buffer_load_dwordx4 v5, s[20:23], s63 offen offset:1024 lds
    buffer_load_dwordx4 v6, s[20:23], s63 offen offset:2048 lds
    buffer_load_dwordx4 v7, s[20:23], s63 offen offset:3072 lds
    s_add_u32 m0, s54, 16384
    s_nop 0
    buffer_load_dwordx4 v8, s[24:27], s57 offen lds
    buffer_load_dwordx4 v9, s[24:27], s57 offen offset:1024 lds
    buffer_load_dwordx4 v8, s[28:31], s57 offen offset:2048 lds
    buffer_load_dwordx4 v9, s[28:31], s57 offen offset:3072 lds
    s_add_u32 s57, s61, 1
    s_and_b32 s57, s57, 3
    s_lshl_b32 s63, s57, 7
    s_add_u32 s63, s63, s52
    s_mul_i32 s57, s57, 229376
    s_add_u32 m0, s54, 32768
    s_add_u32 s57, s57, s53
    buffer_load_dwordx4 v4, s[20:23], s63 offen offset:0 lds
    buffer_load_dwordx4 v5, s[20:23], s63 offen offset:1024 lds
    buffer_load_dwordx4 v6, s[20:23], s63 offen offset:2048 lds
    buffer_load_dwordx4 v7, s[20:23], s63 offen offset:3072 lds
    s_add_u32 m0, s54, 49152
    s_nop 0
    buffer_load_dwordx4 v8, s[24:27], s57 offen lds
    buffer_load_dwordx4 v9, s[24:27], s57 offen offset:1024 lds
    buffer_load_dwordx4 v8, s[28:31], s57 offen offset:2048 lds
    buffer_load_dwordx4 v9, s[28:31], s57 offen offset:3072 lds
    s_add_u32 s57, s61, 2
    s_and_b32 s57, s57, 3
    s_lshl_b32 s63, s57, 7
    s_add_u32 s63, s63, s52
    s_mul_i32 s57, s57, 229376
    s_add_u32 m0, s54, 65536
    s_add_u32 s57, s57, s53
    buffer_load_dwordx4 v4, s[20:23], s63 offen offset:0 lds
    buffer_load_dwordx4 v5, s[20:23], s63 offen offset:1024 lds
    v_and_b32 v16, 1, v3
    v_lshlrev_b32 v16, 1, v16
    v_xor_b32 v16, v16, v2
    v_lshlrev_b32 v16, 4, v16
    v_lshl_add_u32 v10, v1, 10, v16
    v_xor_b32 v11, 64, v10
    v_add_u32 v12, 14336, v10
    v_add_u32 v13, 21504, v11
    v_add_u32 v11, 7168, v11
    s_lshl_b32 s55, s3, 13
    s_mul_i32 s56, s3, 7*65536
    s_lshl_b32 s60, s51, 7
    s_add_u32 s56, s56, s60
    s_mov_b32 s32, s10
    s_and_b32 s33, s11, 0xffff
    s_mov_b32 s34, 0x1c0000
    s_mov_b32 s35, 0x20000
    s_add_u32 s18, s16, 3727360
    s_addc_u32 s19, s17, 0
    s_lshr_b32 s44, s50, 1
    s_lshl_b32 s44, s44, 7
    s_load_dword s46, s[18:19], s44
    s_mov_b32 s36, s16
    s_and_b32 s37, s17, 0xffff
    s_mov_b32 s38, 3762176
    s_mov_b32 s39, 0x20000
    s_mov_b32 s40, s12
    s_and_b32 s41, s13, 0xffff
    s_mov_b32 s42, 0x100000
    s_mov_b32 s43, 0x20000
    v_bfe_u32 v14, v0, 1, 1
    v_and_b32 v15, 1, v1
    v_lshl_add_u32 v14, v15, 1, v14
    v_and_b32 v15, 1, v3
    v_lshl_add_u32 v14, v15, 2, v14
    v_lshlrev_b32 v14, 4, v14
    v_and_b32 v15, 1, v0
    v_lshl_add_u32 v14, v15, 3, v14
    v_bfe_u32 v15, v0, 2, 2
    v_lshl_add_u32 v14, v15, 7, v14
    v_lshl_add_u32 v14, v3, 10, v14
    v_add_u32 v16, s55, v14
    v_xor_b32 v17, 32, v16
    v_xor_b32 v18, 64, v16
    v_xor_b32 v19, 0x60, v16
    v_add_u32 v20, 0x10000, v16
    v_add_u32 v21, 0x10000, v17
    v_add_u32 v22, 0x10000, v18
    v_add_u32 v23, 0x10000, v19
    v_add_u32 v24, 0x20000, v16
    v_add_u32 v25, 0x20000, v17
    v_add_u32 v26, 0x20000, v18
    v_add_u32 v27, 0x20000, v19
    v_lshlrev_b32 v14, 4, v0
    v_lshrrev_b32 v15, 1, v0
    v_lshlrev_b32 v15, 7, v15
    v_and_b32 v252, 1, v0
    v_lshl_add_u32 v15, v252, 2, v15
    s_mul_i32 s47, s44, 28
    s_mul_i32 s60, s3, 7*128
    s_add_u32 s47, s47, s60
    s_add_u32 s47, s47, 3670016
    s_mul_i32 s59, s50, 114688
    s_mul_i32 s60, s3, 7*4096
    s_add_u32 s59, s59, s60
    s_waitcnt vmcnt(10)
    s_barrier
    buffer_load_dwordx4 v6, s[20:23], s63 offen offset:2048 lds
    buffer_load_dwordx4 v7, s[20:23], s63 offen offset:3072 lds
    s_add_u32 m0, s54, 81920
    s_nop 0
    buffer_load_dwordx4 v8, s[24:27], s57 offen lds
    buffer_load_dwordx4 v9, s[24:27], s57 offen offset:1024 lds
    buffer_load_dwordx4 v8, s[28:31], s57 offen offset:2048 lds
    buffer_load_dwordx4 v9, s[28:31], s57 offen offset:3072 lds
    s_add_u32 s57, s61, 3
    s_and_b32 s57, s57, 3
    s_lshl_b32 s63, s57, 7
    s_add_u32 s63, s63, s52
    s_mul_i32 s57, s57, 229376
    s_add_u32 m0, s54, 98304
    s_add_u32 s57, s57, s53
    buffer_load_dwordx4 v4, s[20:23], s63 offen offset:0 lds
    buffer_load_dwordx4 v5, s[20:23], s63 offen offset:1024 lds
    s_waitcnt vmcnt(10)
    s_barrier
    buffer_load_dwordx4 v6, s[20:23], s63 offen offset:2048 lds
    buffer_load_dwordx4 v7, s[20:23], s63 offen offset:3072 lds
    s_add_u32 m0, s54, 114688
    s_nop 0
    buffer_load_dwordx4 v8, s[24:27], s57 offen lds
    buffer_load_dwordx4 v9, s[24:27], s57 offen offset:1024 lds
    buffer_load_dwordx4 v8, s[28:31], s57 offen offset:2048 lds
    buffer_load_dwordx4 v9, s[28:31], s57 offen offset:3072 lds
    s_add_u32 s57, s61, 0
    s_and_b32 s57, s57, 3
    s_add_u32 s57, s57, 4
    s_lshl_b32 s63, s57, 7
    s_add_u32 s63, s63, s52
    s_mul_i32 s57, s57, 229376
    s_add_u32 m0, s54, 131072
    s_add_u32 s57, s57, s53
    buffer_load_dwordx4 v4, s[20:23], s63 offen offset:0 lds
    buffer_load_dwordx4 v5, s[20:23], s63 offen offset:1024 lds
    s_waitcnt vmcnt(10)
    s_barrier
    buffer_load_dwordx4 v6, s[20:23], s63 offen offset:2048 lds
    buffer_load_dwordx4 v7, s[20:23], s63 offen offset:3072 lds
    s_add_u32 m0, s54, 147456
    s_nop 0
    buffer_load_dwordx4 v8, s[24:27], s57 offen lds
    buffer_load_dwordx4 v9, s[24:27], s57 offen offset:1024 lds
    buffer_load_dwordx4 v8, s[28:31], s57 offen offset:2048 lds
    buffer_load_dwordx4 v9, s[28:31], s57 offen offset:3072 lds
    s_add_u32 s57, s61, 1
    s_and_b32 s57, s57, 3
    s_add_u32 s57, s57, 4
    s_lshl_b32 s63, s57, 7
    s_add_u32 s63, s63, s52
    s_mul_i32 s57, s57, 229376
    s_add_u32 m0, s54, 0
    s_add_u32 s57, s57, s53
    buffer_load_dwordx4 v4, s[20:23], s63 offen offset:0 lds
    buffer_load_dwordx4 v5, s[20:23], s63 offen offset:1024 lds
    s_waitcnt vmcnt(10)
    s_barrier
    buffer_load_dwordx4 v6, s[20:23], s63 offen offset:2048 lds
    buffer_load_dwordx4 v7, s[20:23], s63 offen offset:3072 lds
    s_add_u32 m0, s54, 16384
    s_nop 0
    buffer_load_dwordx4 v8, s[24:27], s57 offen lds
    buffer_load_dwordx4 v9, s[24:27], s57 offen offset:1024 lds
    buffer_load_dwordx4 v8, s[28:31], s57 offen offset:2048 lds
    buffer_load_dwordx4 v9, s[28:31], s57 offen offset:3072 lds
    s_add_u32 s57, s61, 2
    s_and_b32 s57, s57, 3
    s_add_u32 s57, s57, 4
    s_lshl_b32 s63, s57, 7
    s_add_u32 s63, s63, s52
    s_mul_i32 s57, s57, 229376
    s_add_u32 m0, s54, 32768
    s_add_u32 s57, s57, s53
    buffer_load_dwordx4 v4, s[20:23], s63 offen offset:0 lds
    buffer_load_dwordx4 v5, s[20:23], s63 offen offset:1024 lds
    s_waitcnt vmcnt(10)
    s_barrier
    buffer_load_dwordx4 v6, s[20:23], s63 offen offset:2048 lds
    buffer_load_dwordx4 v7, s[20:23], s63 offen offset:3072 lds
    s_add_u32 m0, s54, 49152
    s_nop 0
    buffer_load_dwordx4 v8, s[24:27], s57 offen lds
    buffer_load_dwordx4 v9, s[24:27], s57 offen offset:1024 lds
    buffer_load_dwordx4 v8, s[28:31], s57 offen offset:2048 lds
    buffer_load_dwordx4 v9, s[28:31], s57 offen offset:3072 lds
    s_add_u32 s57, s61, 3
    s_and_b32 s57, s57, 3
    s_add_u32 s57, s57, 4
    s_lshl_b32 s63, s57, 7
    s_add_u32 s63, s63, s52
    s_mul_i32 s57, s57, 229376
    s_add_u32 m0, s54, 65536
    s_add_u32 s57, s57, s53
    buffer_load_dwordx4 v4, s[20:23], s63 offen offset:0 lds
    buffer_load_dwordx4 v5, s[20:23], s63 offen offset:1024 lds
    s_waitcnt vmcnt(10)
    s_barrier
    buffer_load_dwordx4 v6, s[20:23], s63 offen offset:2048 lds
    buffer_load_dwordx4 v7, s[20:23], s63 offen offset:3072 lds
    s_add_u32 m0, s54, 81920
    s_nop 0
    buffer_load_dwordx4 v8, s[24:27], s57 offen lds
    buffer_load_dwordx4 v9, s[24:27], s57 offen offset:1024 lds
    buffer_load_dwordx4 v8, s[28:31], s57 offen offset:2048 lds
    buffer_load_dwordx4 v9, s[28:31], s57 offen offset:3072 lds
    s_add_u32 m0, s55, 98304
    s_add_u32 s57, s56, 0
    buffer_load_dwordx4 v10, s[32:35], s57 offen offset:0 lds
    buffer_load_dwordx4 v11, s[32:35], s57 offen offset:1024 lds
    s_waitcnt vmcnt(10)
    s_barrier
    buffer_load_dwordx4 v12, s[32:35], s57 offen offset:2048 lds
    buffer_load_dwordx4 v13, s[32:35], s57 offen offset:3072 lds
    s_add_u32 m0, s55, 102400
    s_add_u32 s57, s57, 32768
    buffer_load_dwordx4 v10, s[32:35], s57 offen offset:0 lds
    buffer_load_dwordx4 v11, s[32:35], s57 offen offset:1024 lds
    buffer_load_dwordx4 v12, s[32:35], s57 offen offset:2048 lds
    buffer_load_dwordx4 v13, s[32:35], s57 offen offset:3072 lds
    s_add_u32 m0, s55, 131072
    s_add_u32 s57, s56, 65536
    buffer_load_dwordx4 v10, s[32:35], s57 offen offset:0 lds
    buffer_load_dwordx4 v11, s[32:35], s57 offen offset:1024 lds
    s_waitcnt vmcnt(10)
    s_barrier
    buffer_load_dwordx4 v12, s[32:35], s57 offen offset:2048 lds
    buffer_load_dwordx4 v13, s[32:35], s57 offen offset:3072 lds
    s_add_u32 m0, s55, 135168
    s_add_u32 s57, s57, 32768
    buffer_load_dwordx4 v10, s[32:35], s57 offen offset:0 lds
    buffer_load_dwordx4 v11, s[32:35], s57 offen offset:1024 lds
    buffer_load_dwordx4 v12, s[32:35], s57 offen offset:2048 lds
    buffer_load_dwordx4 v13, s[32:35], s57 offen offset:3072 lds
    s_waitcnt lgkmcnt(0)
    s_barrier
    s_branch L_load_join
L_load_nop1:
    v_and_b32 v16, 1, v3
    v_lshlrev_b32 v16, 1, v16
    v_xor_b32 v16, v16, v2
    v_lshlrev_b32 v16, 4, v16
    v_lshl_add_u32 v10, v1, 10, v16
    v_xor_b32 v11, 64, v10
    v_add_u32 v12, 14336, v10
    v_add_u32 v13, 21504, v11
    v_add_u32 v11, 7168, v11
    s_lshl_b32 s55, s3, 13
    s_mul_i32 s56, s3, 7*65536
    s_lshl_b32 s60, s51, 7
    s_add_u32 s56, s56, s60
    s_mov_b32 s32, s10
    s_and_b32 s33, s11, 0xffff
    s_mov_b32 s34, 0x1c0000
    s_mov_b32 s35, 0x20000
    s_add_u32 s18, s16, 3727360
    s_addc_u32 s19, s17, 0
    s_lshr_b32 s44, s50, 1
    s_lshl_b32 s44, s44, 7
    s_load_dword s46, s[18:19], s44
    s_mov_b32 s36, s16
    s_and_b32 s37, s17, 0xffff
    s_mov_b32 s38, 3762176
    s_mov_b32 s39, 0x20000
    s_mov_b32 s40, s12
    s_and_b32 s41, s13, 0xffff
    s_mov_b32 s42, 0x100000
    s_mov_b32 s43, 0x20000
    v_bfe_u32 v14, v0, 1, 1
    v_and_b32 v15, 1, v1
    v_lshl_add_u32 v14, v15, 1, v14
    v_and_b32 v15, 1, v3
    v_lshl_add_u32 v14, v15, 2, v14
    v_lshlrev_b32 v14, 4, v14
    v_and_b32 v15, 1, v0
    v_lshl_add_u32 v14, v15, 3, v14
    v_bfe_u32 v15, v0, 2, 2
    v_lshl_add_u32 v14, v15, 7, v14
    v_lshl_add_u32 v14, v3, 10, v14
    v_add_u32 v16, s55, v14
    v_xor_b32 v17, 32, v16
    v_xor_b32 v18, 64, v16
    v_xor_b32 v19, 0x60, v16
    v_add_u32 v20, 0x10000, v16
    v_add_u32 v21, 0x10000, v17
    v_add_u32 v22, 0x10000, v18
    v_add_u32 v23, 0x10000, v19
    v_add_u32 v24, 0x20000, v16
    v_add_u32 v25, 0x20000, v17
    v_add_u32 v26, 0x20000, v18
    v_add_u32 v27, 0x20000, v19
    v_lshlrev_b32 v14, 4, v0
    v_lshrrev_b32 v15, 1, v0
    v_lshlrev_b32 v15, 7, v15
    v_and_b32 v252, 1, v0
    v_lshl_add_u32 v15, v252, 2, v15
    s_mul_i32 s47, s44, 28
    s_mul_i32 s60, s3, 7*128
    s_add_u32 s47, s47, s60
    s_add_u32 s47, s47, 3670016
    s_mul_i32 s59, s50, 114688
    s_mul_i32 s60, s3, 7*4096
    s_add_u32 s59, s59, s60
    s_and_b32 s57, s2, 7
    s_lshl_b32 s57, s57, 2
    s_and_b32 s58, s45, 3
    s_add_u32 s57, s57, s58
    s_lshl_b32 s57, s57, 2
    s_add_u32 s57, s57, s3
    s_mov_b32 s48, s57
    s_mul_i32 s57, s57, 14*1024
    buffer_load_dwordx4 v[92:95], v14, s[32:35], s57 offen offset:0
    buffer_load_dwordx4 v[96:99], v14, s[32:35], s57 offen offset:1024
    buffer_load_dwordx4 v[100:103], v14, s[32:35], s57 offen offset:2048
    buffer_load_dwordx4 v[104:107], v14, s[32:35], s57 offen offset:3072
    s_add_u32 s57, s57, 4096
    buffer_load_dwordx4 v[108:111], v14, s[32:35], s57 offen offset:0
    buffer_load_dwordx4 v[112:115], v14, s[32:35], s57 offen offset:1024
    buffer_load_dwordx4 v[116:119], v14, s[32:35], s57 offen offset:2048
    buffer_load_dwordx4 v[120:123], v14, s[32:35], s57 offen offset:3072
    s_add_u32 s57, s57, 4096
    buffer_load_dwordx4 v[124:127], v14, s[32:35], s57 offen offset:0
    buffer_load_dwordx4 v[128:131], v14, s[32:35], s57 offen offset:1024
    buffer_load_dwordx4 v[132:135], v14, s[32:35], s57 offen offset:2048
    buffer_load_dwordx4 v[136:139], v14, s[32:35], s57 offen offset:3072
    s_add_u32 s57, s57, 4096
    buffer_load_dwordx4 v[140:143], v14, s[32:35], s57 offen offset:0
    buffer_load_dwordx4 v[144:147], v14, s[32:35], s57 offen offset:1024
    s_add_u32 m0, s55, 98304
    s_add_u32 s57, s56, 0
    buffer_load_dwordx4 v10, s[32:35], s57 offen offset:0 lds
    buffer_load_dwordx4 v11, s[32:35], s57 offen offset:1024 lds
    buffer_load_dwordx4 v12, s[32:35], s57 offen offset:2048 lds
    buffer_load_dwordx4 v13, s[32:35], s57 offen offset:3072 lds
    s_add_u32 m0, s55, 102400
    s_add_u32 s57, s57, 32768
    buffer_load_dwordx4 v10, s[32:35], s57 offen offset:0 lds
    buffer_load_dwordx4 v11, s[32:35], s57 offen offset:1024 lds
    buffer_load_dwordx4 v12, s[32:35], s57 offen offset:2048 lds
    buffer_load_dwordx4 v13, s[32:35], s57 offen offset:3072 lds
    s_add_u32 m0, s55, 131072
    s_add_u32 s57, s56, 65536
    buffer_load_dwordx4 v10, s[32:35], s57 offen offset:0 lds
    buffer_load_dwordx4 v11, s[32:35], s57 offen offset:1024 lds
    buffer_load_dwordx4 v12, s[32:35], s57 offen offset:2048 lds
    buffer_load_dwordx4 v13, s[32:35], s57 offen offset:3072 lds
    s_add_u32 m0, s55, 135168
    s_add_u32 s57, s57, 32768
    buffer_load_dwordx4 v10, s[32:35], s57 offen offset:0 lds
    buffer_load_dwordx4 v11, s[32:35], s57 offen offset:1024 lds
    buffer_load_dwordx4 v12, s[32:35], s57 offen offset:2048 lds
    buffer_load_dwordx4 v13, s[32:35], s57 offen offset:3072 lds
    s_waitcnt lgkmcnt(0)
    s_barrier
L_load_join:
    s_mul_i32 s46, s46, 0x9e3779b1
    s_add_u32 s46, s46, 0x7f4a7c15
    v_and_b32 v4, 15, v0
    v_xor_b32 v5, v3, v2
    v_lshlrev_b32 v5, 4, v5
    v_lshl_add_u32 v5, v4, 8, v5
    v_add_u32 v4, s55, v5
    v_xor_b32 v5, 64, v4
    v_lshlrev_b32 v8, 1, v2
    v_xor_b32 v8, v8, v1
    v_lshlrev_b32 v8, 4, v8
    v_lshl_add_u32 v8, v1, 8, v8
    s_lshl_b32 s8, s3, 11
    v_add_u32 v8, s8, v8
    v_xor_b32 v9, 16, v8
    v_lshlrev_b32 v6, 4, v2
    v_lshl_add_u32 v6, v1, 10, v6
    s_lshl_b32 s8, s50, 15
    s_add_u32 s8, s8, s55
    s_lshl_b32 s9, s51, 7
    s_add_u32 s8, s8, s9
    s_add_u32 m0, s55, 0
    s_add_u32 s57, s56, 131072
    buffer_load_dwordx4 v10, s[32:35], s57 offen offset:0 lds
    buffer_load_dwordx4 v11, s[32:35], s57 offen offset:1024 lds
    buffer_load_dwordx4 v12, s[32:35], s57 offen offset:2048 lds
    buffer_load_dwordx4 v13, s[32:35], s57 offen offset:3072 lds
    s_add_u32 m0, s55, 4096
    s_add_u32 s57, s57, 32768
    buffer_load_dwordx4 v10, s[32:35], s57 offen offset:0 lds
    buffer_load_dwordx4 v11, s[32:35], s57 offen offset:1024 lds
    buffer_load_dwordx4 v12, s[32:35], s57 offen offset:2048 lds
    buffer_load_dwordx4 v13, s[32:35], s57 offen offset:3072 lds
    s_waitcnt vmcnt(16)
    ds_read_b64_tr_b16 v[28:29], v20 offset:32768
    ds_read_b64_tr_b16 v[30:31], v20 offset:33280
    ds_read_b64_tr_b16 v[32:33], v21 offset:32768
    ds_read_b64_tr_b16 v[34:35], v21 offset:33280
    ds_read_b64_tr_b16 v[36:37], v22 offset:32768
    ds_read_b64_tr_b16 v[38:39], v22 offset:33280
    ds_read_b64_tr_b16 v[40:41], v23 offset:32768
    ds_read_b64_tr_b16 v[42:43], v23 offset:33280
    ds_read_b64_tr_b16 v[44:45], v20 offset:36864
    ds_read_b64_tr_b16 v[46:47], v20 offset:37376
    ds_read_b64_tr_b16 v[48:49], v21 offset:36864
    ds_read_b64_tr_b16 v[50:51], v21 offset:37376
    ds_read_b64_tr_b16 v[52:53], v22 offset:36864
    ds_read_b64_tr_b16 v[54:55], v22 offset:37376
    ds_read_b64_tr_b16 v[56:57], v23 offset:36864
    ds_read_b64_tr_b16 v[58:59], v23 offset:37376
    s_waitcnt vmcnt(8)
    ds_read_b64_tr_b16 v[60:61], v24 offset:0
    ds_read_b64_tr_b16 v[62:63], v24 offset:512
    ds_read_b64_tr_b16 v[64:65], v25 offset:0
    ds_read_b64_tr_b16 v[66:67], v25 offset:512
    ds_read_b64_tr_b16 v[68:69], v26 offset:0
    ds_read_b64_tr_b16 v[70:71], v26 offset:512
    ds_read_b64_tr_b16 v[72:73], v27 offset:0
    ds_read_b64_tr_b16 v[74:75], v27 offset:512
    ds_read_b64_tr_b16 v[76:77], v24 offset:4096
    ds_read_b64_tr_b16 v[78:79], v24 offset:4608
    ds_read_b64_tr_b16 v[80:81], v25 offset:4096
    ds_read_b64_tr_b16 v[82:83], v25 offset:4608
    ds_read_b64_tr_b16 v[84:85], v26 offset:4096
    ds_read_b64_tr_b16 v[86:87], v26 offset:4608
    ds_read_b64_tr_b16 v[88:89], v27 offset:4096
    ds_read_b64_tr_b16 v[90:91], v27 offset:4608
    s_barrier
    s_add_u32 m0, s55, 32768
    s_add_u32 s57, s56, 196608
    buffer_load_dwordx4 v10, s[32:35], s57 offen offset:0 lds
    buffer_load_dwordx4 v11, s[32:35], s57 offen offset:1024 lds
    buffer_load_dwordx4 v12, s[32:35], s57 offen offset:2048 lds
    buffer_load_dwordx4 v13, s[32:35], s57 offen offset:3072 lds
    s_add_u32 m0, s55, 36864
    s_add_u32 s57, s57, 32768
    buffer_load_dwordx4 v10, s[32:35], s57 offen offset:0 lds
    buffer_load_dwordx4 v11, s[32:35], s57 offen offset:1024 lds
    buffer_load_dwordx4 v12, s[32:35], s57 offen offset:2048 lds
    buffer_load_dwordx4 v13, s[32:35], s57 offen offset:3072 lds
    s_add_u32 m0, s55, 65536
    s_add_u32 s57, s56, 262144
    buffer_load_dwordx4 v10, s[32:35], s57 offen offset:0 lds
    buffer_load_dwordx4 v11, s[32:35], s57 offen offset:1024 lds
    buffer_load_dwordx4 v12, s[32:35], s57 offen offset:2048 lds
    buffer_load_dwordx4 v13, s[32:35], s57 offen offset:3072 lds
    s_add_u32 m0, s55, 69632
    s_add_u32 s57, s57, 32768
    buffer_load_dwordx4 v10, s[32:35], s57 offen offset:0 lds
    buffer_load_dwordx4 v11, s[32:35], s57 offen offset:1024 lds
    buffer_load_dwordx4 v12, s[32:35], s57 offen offset:2048 lds
    buffer_load_dwordx4 v13, s[32:35], s57 offen offset:3072 lds
    s_waitcnt lgkmcnt(0)
    s_add_u32 m0, s55, 98304
    s_add_u32 s57, s56, 327680
    buffer_load_dwordx4 v10, s[32:35], s57 offen offset:0 lds
    buffer_load_dwordx4 v11, s[32:35], s57 offen offset:1024 lds
    buffer_load_dwordx4 v12, s[32:35], s57 offen offset:2048 lds
    buffer_load_dwordx4 v13, s[32:35], s57 offen offset:3072 lds
    s_add_u32 m0, s55, 102400
    s_add_u32 s57, s57, 32768
    buffer_load_dwordx4 v10, s[32:35], s57 offen offset:0 lds
    buffer_load_dwordx4 v11, s[32:35], s57 offen offset:1024 lds
    buffer_load_dwordx4 v12, s[32:35], s57 offen offset:2048 lds
    buffer_load_dwordx4 v13, s[32:35], s57 offen offset:3072 lds
    s_mov_b64 exec, 0x3fff
    buffer_load_dword v252, v15, s[36:39], s47 offen sc1
    s_mov_b64 exec, -1
    s_waitcnt lgkmcnt(0)
    s_add_u32 m0, s55, 131072
    s_add_u32 s57, s56, 393216
    buffer_load_dwordx4 v10, s[32:35], s57 offen offset:0 lds
    buffer_load_dwordx4 v11, s[32:35], s57 offen offset:1024 lds
    buffer_load_dwordx4 v12, s[32:35], s57 offen offset:2048 lds
    buffer_load_dwordx4 v13, s[32:35], s57 offen offset:3072 lds
    s_add_u32 m0, s55, 135168
    s_add_u32 s57, s57, 32768
    buffer_load_dwordx4 v10, s[32:35], s57 offen offset:0 lds
    buffer_load_dwordx4 v11, s[32:35], s57 offen offset:1024 lds
    buffer_load_dwordx4 v12, s[32:35], s57 offen offset:2048 lds
    buffer_load_dwordx4 v13, s[32:35], s57 offen offset:3072 lds
    s_mov_b32 s57, 0
    s_mov_b64 exec, 0x3fff
    s_waitcnt vmcnt(8)
    v_cmp_ne_u32 vcc, s46, v252
    s_nop 0
    s_cbranch_vccz L_lpoll_done
    s_cmp_lg_u32 vcc_lo, 0x3fff
    s_cbranch_scc1 L_lpoll_loop
    s_mov_b64 exec, -1
    s_cmp_lt_u32 s45, 28
    s_cbranch_scc1 L_nohelp
    s_add_u32 s60, s51, 3
    s_and_b32 s60, s60, 3
    s_and_b32 s61, s51, 3
    s_sub_u32 s60, s60, s61
    s_lshl_b32 s60, s60, 7
    s_add_u32 s60, s60, s56
    s_add_u32 s60, s60, 393216
    s_add_u32 s61, s60, 32768
    buffer_load_dwordx4 v[92:95], v10, s[32:35], s60 offen offset:0
    buffer_load_dwordx4 v[96:99], v11, s[32:35], s60 offen offset:1024
    buffer_load_dwordx4 v[100:103], v12, s[32:35], s60 offen offset:2048
    buffer_load_dwordx4 v[104:107], v13, s[32:35], s60 offen offset:3072
    buffer_load_dwordx4 v[108:111], v10, s[32:35], s61 offen offset:0
    buffer_load_dwordx4 v[112:115], v11, s[32:35], s61 offen offset:1024
    buffer_load_dwordx4 v[116:119], v12, s[32:35], s61 offen offset:2048
    buffer_load_dwordx4 v[120:123], v13, s[32:35], s61 offen offset:3072
    s_add_u32 s60, s51, 2
    s_and_b32 s60, s60, 3
    s_and_b32 s61, s51, 3
    s_sub_u32 s60, s60, s61
    s_lshl_b32 s60, s60, 7
    s_add_u32 s60, s60, s56
    s_add_u32 s60, s60, 327680
    s_add_u32 s61, s60, 32768
    buffer_load_dwordx4 v[124:127], v10, s[32:35], s60 offen offset:0
    buffer_load_dwordx4 v[128:131], v11, s[32:35], s60 offen offset:1024
    buffer_load_dwordx4 v[132:135], v12, s[32:35], s60 offen offset:2048
    buffer_load_dwordx4 v[136:139], v13, s[32:35], s60 offen offset:3072
    buffer_load_dwordx4 v[140:143], v10, s[32:35], s61 offen offset:0
    buffer_load_dwordx4 v[144:147], v11, s[32:35], s61 offen offset:1024
    buffer_load_dwordx4 v[148:151], v12, s[32:35], s61 offen offset:2048
    buffer_load_dwordx4 v[152:155], v13, s[32:35], s61 offen offset:3072
    s_add_u32 s60, s51, 1
    s_and_b32 s60, s60, 3
    s_and_b32 s61, s51, 3
    s_sub_u32 s60, s60, s61
    s_lshl_b32 s60, s60, 7
    s_add_u32 s60, s60, s56
    s_add_u32 s60, s60, 262144
    s_add_u32 s61, s60, 32768
    buffer_load_dwordx4 v[156:159], v10, s[32:35], s60 offen offset:0
    buffer_load_dwordx4 v[160:163], v11, s[32:35], s60 offen offset:1024
    buffer_load_dwordx4 v[164:167], v12, s[32:35], s60 offen offset:2048
    buffer_load_dwordx4 v[168:171], v13, s[32:35], s60 offen offset:3072
    buffer_load_dwordx4 v[172:175], v10, s[32:35], s61 offen offset:0
    buffer_load_dwordx4 v[176:179], v11, s[32:35], s61 offen offset:1024
    buffer_load_dwordx4 v[180:183], v12, s[32:35], s61 offen offset:2048
    buffer_load_dwordx4 v[184:187], v13, s[32:35], s61 offen offset:3072
L_nohelp:
    s_mov_b64 exec, 1
L_lpoll_one:
    buffer_load_dword v252, v15, s[36:39], s47 offen sc1
    s_add_u32 s57, s57, 1
    s_waitcnt vmcnt(0)
    v_cmp_ne_u32 vcc, s46, v252
    s_cmp_ge_u32 s57, 0x40000
    s_cbranch_scc1 L_lpoll_full
    s_cbranch_vccz L_lpoll_full
    s_sleep 8
    s_branch L_lpoll_one
L_lpoll_full:
    s_mov_b64 exec, 0x3fff
L_lpoll_loop:
    buffer_load_dword v252, v15, s[36:39], s47 offen sc1
    s_add_u32 s57, s57, 1
    s_waitcnt vmcnt(0)
    v_cmp_ne_u32 vcc, s46, v252
    s_cmp_ge_u32 s57, 0x40000
    s_cbranch_scc1 L_lpoll_done
    s_cbranch_vccz L_lpoll_done
    s_sleep 1
    s_branch L_lpoll_loop
L_lpoll_done:
    s_mov_b64 exec, -1
    s_add_u32 s58, s59, 0
    buffer_load_dwordx4 v[92:95], v14, s[36:39], s58 offen offset:0 sc1
    buffer_load_dwordx4 v[96:99], v14, s[36:39], s58 offen offset:1024 sc1
    buffer_load_dwordx4 v[100:103], v14, s[36:39], s58 offen offset:2048 sc1
    buffer_load_dwordx4 v[104:107], v14, s[36:39], s58 offen offset:3072 sc1
    s_add_u32 s58, s59, 4096
    buffer_load_dwordx4 v[108:111], v14, s[36:39], s58 offen offset:0 sc1
    buffer_load_dwordx4 v[112:115], v14, s[36:39], s58 offen offset:1024 sc1
    buffer_load_dwordx4 v[116:119], v14, s[36:39], s58 offen offset:2048 sc1
    buffer_load_dwordx4 v[120:123], v14, s[36:39], s58 offen offset:3072 sc1
    s_add_u32 s58, s59, 8192
    buffer_load_dwordx4 v[124:127], v14, s[36:39], s58 offen offset:0 sc1
    buffer_load_dwordx4 v[128:131], v14, s[36:39], s58 offen offset:1024 sc1
    buffer_load_dwordx4 v[132:135], v14, s[36:39], s58 offen offset:2048 sc1
    buffer_load_dwordx4 v[136:139], v14, s[36:39], s58 offen offset:3072 sc1
    s_waitcnt vmcnt(11)
    v_mfma_f32_16x16x32_bf16 v[188:191], v[28:31], v[92:95], 0
    v_mfma_f32_16x16x32_bf16 v[192:195], v[32:35], v[92:95], 0
    v_mfma_f32_16x16x32_bf16 v[196:199], v[36:39], v[92:95], 0
    v_mfma_f32_16x16x32_bf16 v[200:203], v[40:43], v[92:95], 0
    s_add_u32 s58, s59, 12288
    buffer_load_dwordx4 v[140:143], v14, s[36:39], s58 offen offset:0 sc1
    s_waitcnt vmcnt(11)
    v_mfma_f32_16x16x32_bf16 v[216:219], v[40:43], v[96:99], 0
    v_mfma_f32_16x16x32_bf16 v[212:215], v[36:39], v[96:99], 0
    v_mfma_f32_16x16x32_bf16 v[208:211], v[32:35], v[96:99], 0
    v_mfma_f32_16x16x32_bf16 v[204:207], v[28:31], v[96:99], 0
    buffer_load_dwordx4 v[144:147], v14, s[36:39], s58 offen offset:1024 sc1
    s_waitcnt vmcnt(11)
    v_mfma_f32_16x16x32_bf16 v[188:191], v[44:47], v[100:103], v[188:191]
    v_mfma_f32_16x16x32_bf16 v[192:195], v[48:51], v[100:103], v[192:195]
    v_mfma_f32_16x16x32_bf16 v[196:199], v[52:55], v[100:103], v[196:199]
    v_mfma_f32_16x16x32_bf16 v[200:203], v[56:59], v[100:103], v[200:203]
    buffer_load_dwordx4 v[148:151], v14, s[36:39], s58 offen offset:2048 sc1
    s_waitcnt vmcnt(11)
    v_mfma_f32_16x16x32_bf16 v[216:219], v[56:59], v[104:107], v[216:219]
    v_mfma_f32_16x16x32_bf16 v[212:215], v[52:55], v[104:107], v[212:215]
    v_mfma_f32_16x16x32_bf16 v[208:211], v[48:51], v[104:107], v[208:211]
    v_mfma_f32_16x16x32_bf16 v[204:207], v[44:47], v[104:107], v[204:207]
    buffer_load_dwordx4 v[152:155], v14, s[36:39], s58 offen offset:3072 sc1
    s_waitcnt vmcnt(11)
    v_mfma_f32_16x16x32_bf16 v[188:191], v[60:63], v[108:111], v[188:191]
    v_mfma_f32_16x16x32_bf16 v[192:195], v[64:67], v[108:111], v[192:195]
    v_mfma_f32_16x16x32_bf16 v[196:199], v[68:71], v[108:111], v[196:199]
    v_mfma_f32_16x16x32_bf16 v[200:203], v[72:75], v[108:111], v[200:203]
    s_add_u32 s58, s59, 16384
    buffer_load_dwordx4 v[156:159], v14, s[36:39], s58 offen offset:0 sc1
    s_waitcnt vmcnt(11)
    v_mfma_f32_16x16x32_bf16 v[216:219], v[72:75], v[112:115], v[216:219]
    v_mfma_f32_16x16x32_bf16 v[212:215], v[68:71], v[112:115], v[212:215]
    v_mfma_f32_16x16x32_bf16 v[208:211], v[64:67], v[112:115], v[208:211]
    v_mfma_f32_16x16x32_bf16 v[204:207], v[60:63], v[112:115], v[204:207]
    buffer_load_dwordx4 v[160:163], v14, s[36:39], s58 offen offset:1024 sc1
    s_waitcnt vmcnt(11)
    v_mfma_f32_16x16x32_bf16 v[188:191], v[76:79], v[116:119], v[188:191]
    ds_read_b64_tr_b16 v[220:221], v16 offset:0
    ds_read_b64_tr_b16 v[222:223], v16 offset:512
    v_mfma_f32_16x16x32_bf16 v[192:195], v[80:83], v[116:119], v[192:195]
    ds_read_b64_tr_b16 v[224:225], v17 offset:0
    ds_read_b64_tr_b16 v[226:227], v17 offset:512
    v_mfma_f32_16x16x32_bf16 v[196:199], v[84:87], v[116:119], v[196:199]
    ds_read_b64_tr_b16 v[228:229], v18 offset:0
    ds_read_b64_tr_b16 v[230:231], v18 offset:512
    v_mfma_f32_16x16x32_bf16 v[200:203], v[88:91], v[116:119], v[200:203]
    ds_read_b64_tr_b16 v[232:233], v19 offset:0
    ds_read_b64_tr_b16 v[234:235], v19 offset:512
    buffer_load_dwordx4 v[164:167], v14, s[36:39], s58 offen offset:2048 sc1
    s_waitcnt vmcnt(11)
    v_mfma_f32_16x16x32_bf16 v[216:219], v[88:91], v[120:123], v[216:219]
    v_mfma_f32_16x16x32_bf16 v[212:215], v[84:87], v[120:123], v[212:215]
    v_mfma_f32_16x16x32_bf16 v[208:211], v[80:83], v[120:123], v[208:211]
    v_mfma_f32_16x16x32_bf16 v[204:207], v[76:79], v[120:123], v[204:207]
    buffer_load_dwordx4 v[168:171], v14, s[36:39], s58 offen offset:3072 sc1
    s_waitcnt vmcnt(11) lgkmcnt(0)
    v_mfma_f32_16x16x32_bf16 v[188:191], v[220:223], v[124:127], v[188:191]
    ds_read_b64_tr_b16 v[236:237], v16 offset:4096
    ds_read_b64_tr_b16 v[238:239], v16 offset:4608
    v_mfma_f32_16x16x32_bf16 v[192:195], v[224:227], v[124:127], v[192:195]
    ds_read_b64_tr_b16 v[240:241], v17 offset:4096
    ds_read_b64_tr_b16 v[242:243], v17 offset:4608
    v_mfma_f32_16x16x32_bf16 v[196:199], v[228:231], v[124:127], v[196:199]
    ds_read_b64_tr_b16 v[244:245], v18 offset:4096
    ds_read_b64_tr_b16 v[246:247], v18 offset:4608
    v_mfma_f32_16x16x32_bf16 v[200:203], v[232:235], v[124:127], v[200:203]
    ds_read_b64_tr_b16 v[248:249], v19 offset:4096
    ds_read_b64_tr_b16 v[250:251], v19 offset:4608
    s_add_u32 s58, s59, 20480
    buffer_load_dwordx4 v[172:175], v14, s[36:39], s58 offen offset:0 sc1
    s_waitcnt vmcnt(11)
    v_mfma_f32_16x16x32_bf16 v[216:219], v[232:235], v[128:131], v[216:219]
    v_mfma_f32_16x16x32_bf16 v[212:215], v[228:231], v[128:131], v[212:215]
    v_mfma_f32_16x16x32_bf16 v[208:211], v[224:227], v[128:131], v[208:211]
    v_mfma_f32_16x16x32_bf16 v[204:207], v[220:223], v[128:131], v[204:207]
    buffer_load_dwordx4 v[176:179], v14, s[36:39], s58 offen offset:1024 sc1
    s_waitcnt vmcnt(11) lgkmcnt(0)
    v_mfma_f32_16x16x32_bf16 v[188:191], v[236:239], v[132:135], v[188:191]
    ds_read_b64_tr_b16 v[220:221], v16 offset:32768
    ds_read_b64_tr_b16 v[222:223], v16 offset:33280
    v_mfma_f32_16x16x32_bf16 v[192:195], v[240:243], v[132:135], v[192:195]
    ds_read_b64_tr_b16 v[224:225], v17 offset:32768
    ds_read_b64_tr_b16 v[226:227], v17 offset:33280
    v_mfma_f32_16x16x32_bf16 v[196:199], v[244:247], v[132:135], v[196:199]
    ds_read_b64_tr_b16 v[228:229], v18 offset:32768
    ds_read_b64_tr_b16 v[230:231], v18 offset:33280
    v_mfma_f32_16x16x32_bf16 v[200:203], v[248:251], v[132:135], v[200:203]
    ds_read_b64_tr_b16 v[232:233], v19 offset:32768
    ds_read_b64_tr_b16 v[234:235], v19 offset:33280
    buffer_load_dwordx4 v[180:183], v14, s[36:39], s58 offen offset:2048 sc1
    s_waitcnt vmcnt(11)
    v_mfma_f32_16x16x32_bf16 v[216:219], v[248:251], v[136:139], v[216:219]
    v_mfma_f32_16x16x32_bf16 v[212:215], v[244:247], v[136:139], v[212:215]
    v_mfma_f32_16x16x32_bf16 v[208:211], v[240:243], v[136:139], v[208:211]
    v_mfma_f32_16x16x32_bf16 v[204:207], v[236:239], v[136:139], v[204:207]
    buffer_load_dwordx4 v[184:187], v14, s[36:39], s58 offen offset:3072 sc1
    s_waitcnt vmcnt(11) lgkmcnt(0)
    v_mfma_f32_16x16x32_bf16 v[188:191], v[220:223], v[140:143], v[188:191]
    ds_read_b64_tr_b16 v[236:237], v16 offset:36864
    ds_read_b64_tr_b16 v[238:239], v16 offset:37376
    v_mfma_f32_16x16x32_bf16 v[192:195], v[224:227], v[140:143], v[192:195]
    ds_read_b64_tr_b16 v[240:241], v17 offset:36864
    ds_read_b64_tr_b16 v[242:243], v17 offset:37376
    v_mfma_f32_16x16x32_bf16 v[196:199], v[228:231], v[140:143], v[196:199]
    ds_read_b64_tr_b16 v[244:245], v18 offset:36864
    ds_read_b64_tr_b16 v[246:247], v18 offset:37376
    v_mfma_f32_16x16x32_bf16 v[200:203], v[232:235], v[140:143], v[200:203]
    ds_read_b64_tr_b16 v[248:249], v19 offset:36864
    ds_read_b64_tr_b16 v[250:251], v19 offset:37376
    s_add_u32 s58, s59, 24576
    buffer_load_dwordx4 v[92:95], v14, s[36:39], s58 offen offset:0 sc1
    s_waitcnt vmcnt(11)
    v_mfma_f32_16x16x32_bf16 v[216:219], v[232:235], v[144:147], v[216:219]
    v_mfma_f32_16x16x32_bf16 v[212:215], v[228:231], v[144:147], v[212:215]
    v_mfma_f32_16x16x32_bf16 v[208:211], v[224:227], v[144:147], v[208:211]
    v_mfma_f32_16x16x32_bf16 v[204:207], v[220:223], v[144:147], v[204:207]
    buffer_load_dwordx4 v[96:99], v14, s[36:39], s58 offen offset:1024 sc1
    s_waitcnt vmcnt(11) lgkmcnt(0)
    v_mfma_f32_16x16x32_bf16 v[188:191], v[236:239], v[148:151], v[188:191]
    ds_read_b64_tr_b16 v[220:221], v20 offset:0
    ds_read_b64_tr_b16 v[222:223], v20 offset:512
    v_mfma_f32_16x16x32_bf16 v[192:195], v[240:243], v[148:151], v[192:195]
    ds_read_b64_tr_b16 v[224:225], v21 offset:0
    ds_read_b64_tr_b16 v[226:227], v21 offset:512
    v_mfma_f32_16x16x32_bf16 v[196:199], v[244:247], v[148:151], v[196:199]
    ds_read_b64_tr_b16 v[228:229], v22 offset:0
    ds_read_b64_tr_b16 v[230:231], v22 offset:512
    v_mfma_f32_16x16x32_bf16 v[200:203], v[248:251], v[148:151], v[200:203]
    ds_read_b64_tr_b16 v[232:233], v23 offset:0
    ds_read_b64_tr_b16 v[234:235], v23 offset:512
    buffer_load_dwordx4 v[100:103], v14, s[36:39], s58 offen offset:2048 sc1
    s_waitcnt vmcnt(11)
    v_mfma_f32_16x16x32_bf16 v[216:219], v[248:251], v[152:155], v[216:219]
    v_mfma_f32_16x16x32_bf16 v[212:215], v[244:247], v[152:155], v[212:215]
    v_mfma_f32_16x16x32_bf16 v[208:211], v[240:243], v[152:155], v[208:211]
    v_mfma_f32_16x16x32_bf16 v[204:207], v[236:239], v[152:155], v[204:207]
    buffer_load_dwordx4 v[104:107], v14, s[36:39], s58 offen offset:3072 sc1
    s_waitcnt vmcnt(11) lgkmcnt(0)
    v_mfma_f32_16x16x32_bf16 v[188:191], v[220:223], v[156:159], v[188:191]
    ds_read_b64_tr_b16 v[236:237], v20 offset:4096
    ds_read_b64_tr_b16 v[238:239], v20 offset:4608
    v_mfma_f32_16x16x32_bf16 v[192:195], v[224:227], v[156:159], v[192:195]
    ds_read_b64_tr_b16 v[240:241], v21 offset:4096
    ds_read_b64_tr_b16 v[242:243], v21 offset:4608
    v_mfma_f32_16x16x32_bf16 v[196:199], v[228:231], v[156:159], v[196:199]
    ds_read_b64_tr_b16 v[244:245], v22 offset:4096
    ds_read_b64_tr_b16 v[246:247], v22 offset:4608
    v_mfma_f32_16x16x32_bf16 v[200:203], v[232:235], v[156:159], v[200:203]
    ds_read_b64_tr_b16 v[248:249], v23 offset:4096
    ds_read_b64_tr_b16 v[250:251], v23 offset:4608
    s_waitcnt vmcnt(10)
    v_mfma_f32_16x16x32_bf16 v[216:219], v[232:235], v[160:163], v[216:219]
    v_mfma_f32_16x16x32_bf16 v[212:215], v[228:231], v[160:163], v[212:215]
    v_mfma_f32_16x16x32_bf16 v[208:211], v[224:227], v[160:163], v[208:211]
    v_mfma_f32_16x16x32_bf16 v[204:207], v[220:223], v[160:163], v[204:207]
    s_waitcnt vmcnt(9) lgkmcnt(0)
    v_mfma_f32_16x16x32_bf16 v[188:191], v[236:239], v[164:167], v[188:191]
    ds_read_b64_tr_b16 v[220:221], v20 offset:32768
    ds_read_b64_tr_b16 v[222:223], v20 offset:33280
    v_mfma_f32_16x16x32_bf16 v[192:195], v[240:243], v[164:167], v[192:195]
    ds_read_b64_tr_b16 v[224:225], v21 offset:32768
    ds_read_b64_tr_b16 v[226:227], v21 offset:33280
    v_mfma_f32_16x16x32_bf16 v[196:199], v[244:247], v[164:167], v[196:199]
    ds_read_b64_tr_b16 v[228:229], v22 offset:32768
    ds_read_b64_tr_b16 v[230:231], v22 offset:33280
    v_mfma_f32_16x16x32_bf16 v[200:203], v[248:251], v[164:167], v[200:203]
    ds_read_b64_tr_b16 v[232:233], v23 offset:32768
    ds_read_b64_tr_b16 v[234:235], v23 offset:33280
    s_waitcnt vmcnt(8)
    v_mfma_f32_16x16x32_bf16 v[216:219], v[248:251], v[168:171], v[216:219]
    v_mfma_f32_16x16x32_bf16 v[212:215], v[244:247], v[168:171], v[212:215]
    v_mfma_f32_16x16x32_bf16 v[208:211], v[240:243], v[168:171], v[208:211]
    v_mfma_f32_16x16x32_bf16 v[204:207], v[236:239], v[168:171], v[204:207]
    s_waitcnt vmcnt(7) lgkmcnt(0)
    v_mfma_f32_16x16x32_bf16 v[188:191], v[220:223], v[172:175], v[188:191]
    ds_read_b64_tr_b16 v[236:237], v20 offset:36864
    ds_read_b64_tr_b16 v[238:239], v20 offset:37376
    v_mfma_f32_16x16x32_bf16 v[192:195], v[224:227], v[172:175], v[192:195]
    ds_read_b64_tr_b16 v[240:241], v21 offset:36864
    ds_read_b64_tr_b16 v[242:243], v21 offset:37376
    v_mfma_f32_16x16x32_bf16 v[196:199], v[228:231], v[172:175], v[196:199]
    ds_read_b64_tr_b16 v[244:245], v22 offset:36864
    ds_read_b64_tr_b16 v[246:247], v22 offset:37376
    v_mfma_f32_16x16x32_bf16 v[200:203], v[232:235], v[172:175], v[200:203]
    ds_read_b64_tr_b16 v[248:249], v23 offset:36864
    ds_read_b64_tr_b16 v[250:251], v23 offset:37376
    s_waitcnt vmcnt(6)
    v_mfma_f32_16x16x32_bf16 v[216:219], v[232:235], v[176:179], v[216:219]
    v_mfma_f32_16x16x32_bf16 v[212:215], v[228:231], v[176:179], v[212:215]
    v_mfma_f32_16x16x32_bf16 v[208:211], v[224:227], v[176:179], v[208:211]
    v_mfma_f32_16x16x32_bf16 v[204:207], v[220:223], v[176:179], v[204:207]
    s_waitcnt vmcnt(5) lgkmcnt(0)
    v_mfma_f32_16x16x32_bf16 v[188:191], v[236:239], v[180:183], v[188:191]
    ds_read_b64_tr_b16 v[220:221], v24 offset:0
    ds_read_b64_tr_b16 v[222:223], v24 offset:512
    v_mfma_f32_16x16x32_bf16 v[192:195], v[240:243], v[180:183], v[192:195]
    ds_read_b64_tr_b16 v[224:225], v25 offset:0
    ds_read_b64_tr_b16 v[226:227], v25 offset:512
    v_mfma_f32_16x16x32_bf16 v[196:199], v[244:247], v[180:183], v[196:199]
    ds_read_b64_tr_b16 v[228:229], v26 offset:0
    ds_read_b64_tr_b16 v[230:231], v26 offset:512
    v_mfma_f32_16x16x32_bf16 v[200:203], v[248:251], v[180:183], v[200:203]
    ds_read_b64_tr_b16 v[232:233], v27 offset:0
    ds_read_b64_tr_b16 v[234:235], v27 offset:512
    s_waitcnt vmcnt(4)
    v_mfma_f32_16x16x32_bf16 v[216:219], v[248:251], v[184:187], v[216:219]
    v_mfma_f32_16x16x32_bf16 v[212:215], v[244:247], v[184:187], v[212:215]
    v_mfma_f32_16x16x32_bf16 v[208:211], v[240:243], v[184:187], v[208:211]
    v_mfma_f32_16x16x32_bf16 v[204:207], v[236:239], v[184:187], v[204:207]
    s_waitcnt vmcnt(3) lgkmcnt(0)
    v_mfma_f32_16x16x32_bf16 v[188:191], v[220:223], v[92:95], v[188:191]
    ds_read_b64_tr_b16 v[236:237], v24 offset:4096
    ds_read_b64_tr_b16 v[238:239], v24 offset:4608
    v_mfma_f32_16x16x32_bf16 v[192:195], v[224:227], v[92:95], v[192:195]
    ds_read_b64_tr_b16 v[240:241], v25 offset:4096
    ds_read_b64_tr_b16 v[242:243], v25 offset:4608
    v_mfma_f32_16x16x32_bf16 v[196:199], v[228:231], v[92:95], v[196:199]
    ds_read_b64_tr_b16 v[244:245], v26 offset:4096
    ds_read_b64_tr_b16 v[246:247], v26 offset:4608
    v_mfma_f32_16x16x32_bf16 v[200:203], v[232:235], v[92:95], v[200:203]
    ds_read_b64_tr_b16 v[248:249], v27 offset:4096
    ds_read_b64_tr_b16 v[250:251], v27 offset:4608
    s_waitcnt vmcnt(2)
    v_mfma_f32_16x16x32_bf16 v[216:219], v[232:235], v[96:99], v[216:219]
    v_mfma_f32_16x16x32_bf16 v[212:215], v[228:231], v[96:99], v[212:215]
    v_mfma_f32_16x16x32_bf16 v[208:211], v[224:227], v[96:99], v[208:211]
    v_mfma_f32_16x16x32_bf16 v[204:207], v[220:223], v[96:99], v[204:207]
    s_waitcnt vmcnt(1) lgkmcnt(0)
    v_mfma_f32_16x16x32_bf16 v[188:191], v[236:239], v[100:103], v[188:191]
    v_mfma_f32_16x16x32_bf16 v[192:195], v[240:243], v[100:103], v[192:195]
    v_mfma_f32_16x16x32_bf16 v[196:199], v[244:247], v[100:103], v[196:199]
    v_mfma_f32_16x16x32_bf16 v[200:203], v[248:251], v[100:103], v[200:203]
    s_waitcnt vmcnt(0)
    v_mfma_f32_16x16x32_bf16 v[216:219], v[248:251], v[104:107], v[216:219]
    v_mfma_f32_16x16x32_bf16 v[212:215], v[244:247], v[104:107], v[212:215]
    v_mfma_f32_16x16x32_bf16 v[208:211], v[240:243], v[104:107], v[208:211]
    v_mfma_f32_16x16x32_bf16 v[204:207], v[236:239], v[104:107], v[204:207]
    s_nop 0
    ds_write_b128 v4, v[188:191] offset:0
    ds_write_b128 v5, v[192:195] offset:0
    ds_write_b128 v4, v[196:199] offset:128
    ds_write_b128 v5, v[200:203] offset:128
    ds_write_b128 v5, v[216:219] offset:4224
    ds_write_b128 v4, v[212:215] offset:4224
    ds_write_b128 v5, v[208:211] offset:4096
    ds_write_b128 v4, v[204:207] offset:4096
    s_waitcnt lgkmcnt(0)
    s_barrier
    ds_read_b128 v[28:31], v8 offset:0
    ds_read_b128 v[32:35], v9 offset:0
    ds_read_b128 v[36:39], v8 offset:8192
    ds_read_b128 v[40:43], v9 offset:8192
    ds_read_b128 v[44:47], v8 offset:16384
    ds_read_b128 v[48:51], v9 offset:16384
    ds_read_b128 v[52:55], v8 offset:24576
    ds_read_b128 v[56:59], v9 offset:24576
    s_waitcnt lgkmcnt(4)
    v_pk_add_f32 v[28:29], v[28:29], v[36:37]
    v_pk_add_f32 v[30:31], v[30:31], v[38:39]
    v_pk_add_f32 v[32:33], v[32:33], v[40:41]
    v_pk_add_f32 v[34:35], v[34:35], v[42:43]
    s_waitcnt lgkmcnt(0)
    v_pk_add_f32 v[44:45], v[44:45], v[52:53]
    v_pk_add_f32 v[46:47], v[46:47], v[54:55]
    v_pk_add_f32 v[48:49], v[48:49], v[56:57]
    v_pk_add_f32 v[50:51], v[50:51], v[58:59]
    v_pk_add_f32 v[28:29], v[28:29], v[44:45]
    v_pk_add_f32 v[30:31], v[30:31], v[46:47]
    v_pk_add_f32 v[32:33], v[32:33], v[48:49]
    v_pk_add_f32 v[34:35], v[34:35], v[50:51]
    v_cvt_pk_bf16_f32 v60, v28, v29
    v_cvt_pk_bf16_f32 v61, v30, v31
    v_cvt_pk_bf16_f32 v62, v32, v33
    v_cvt_pk_bf16_f32 v63, v34, v35
    buffer_store_dwordx4 v[60:63], v6, s[40:43], s8 offen
    s_endpgm
L_compute:
    s_and_b32 s52, s3, 1
    s_bfe_u32 s53, s3, 0x10001
    v_and_b32 v22, 15, v0
    v_bfe_u32 v23, v0, 1, 3
    v_xor_b32 v23, v23, v3
    v_lshlrev_b32 v23, 4, v23
    v_lshl_add_u32 v23, v22, 7, v23
    s_lshl_b32 s54, s52, 13
    v_add_u32 v4, s54, v23
    v_xor_b32 v5, 64, v4
    v_add_u32 v6, 0x10000, v4
    v_add_u32 v7, 0x10000, v5
    v_add_u32 v8, 0x20000, v4
    v_add_u32 v9, 0x20000, v5
    v_bfe_u32 v20, v0, 1, 1
    s_lshl_b32 s54, s53, 2
    v_or_b32 v20, s54, v20
    v_and_b32 v21, 1, v1
    v_lshlrev_b32 v21, 1, v21
    v_xor_b32 v20, v20, v21
    v_and_b32 v21, 1, v3
    v_lshlrev_b32 v23, 2, v21
    v_xor_b32 v20, v20, v23
    v_lshlrev_b32 v20, 4, v20
    v_and_b32 v23, 1, v0
    v_lshl_add_u32 v20, v23, 3, v20
    v_bfe_u32 v23, v0, 2, 2
    v_lshl_add_u32 v20, v23, 7, v20
    v_lshl_add_u32 v20, v21, 10, v20
    v_lshrrev_b32 v23, 5, v0
    v_lshl_add_u32 v20, v23, 12, v20
    v_add_u32 v10, 0x4000, v20
    v_xor_b32 v11, 32, v10
    v_add_u32 v12, 0x10000, v10
    v_add_u32 v13, 0x10000, v11
    v_add_u32 v14, 0x20000, v10
    v_add_u32 v15, 0x20000, v11
    v_lshl_add_u32 v23, v21, 1, v23
    v_lshlrev_b32 v22, 4, v22
    v_lshl_add_u32 v22, v23, 8, v22
    s_lshl_b32 s20, s14, 1
    s_add_u32 s20, s20, s52
    s_lshl_b32 s56, s20, 7
    s_lshr_b32 s57, s50, 1
    s_lshl_b32 s57, s57, 7
    s_lshl_b32 s21, s20, 1
    s_mul_i32 s21, s21, 114688
    s_lshl_b32 s22, s49, 12
    s_add_u32 s21, s21, s22
    s_lshl_b32 s22, s53, 11
    s_add_u32 s21, s21, s22
    s_add_u32 s22, s21, 114688
    s_mul_i32 s23, s20, 28
    s_add_u32 s23, s23, s49
    s_lshl_b32 s23, s23, 7
    s_lshl_b32 s24, s53, 2
    s_add_u32 s23, s23, s24
    s_add_u32 s23, s23, 3670016
    s_mov_b32 s58, 0xbfb8aa3b
    s_mov_b32 s59, 0xbfb8aa3b
    s_mov_b32 s60, 1.0
    s_mov_b32 s61, 1.0
    s_waitcnt lgkmcnt(0)
    s_add_u32 s18, s16, 3727360
    s_addc_u32 s19, s17, 0
    s_load_dword s55, s[18:19], s56
    s_load_dword s54, s[18:19], s57
    s_mov_b32 s36, s16
    s_and_b32 s37, s17, 0xffff
    s_mov_b32 s38, 3762176
    s_mov_b32 s39, 0x20000
    s_cmp_ge_u32 s45, 28
    s_cbranch_scc1 L_nop1_compute
    s_barrier
    ds_read_b128 v[24:27], v4 offset:0
    ds_read_b64_tr_b16 v[40:41], v10 offset:0
    ds_read_b64_tr_b16 v[42:43], v10 offset:512
    ds_read_b64_tr_b16 v[44:45], v11 offset:0
    ds_read_b64_tr_b16 v[46:47], v11 offset:512
    ds_read_b64_tr_b16 v[48:49], v10 offset:2048
    ds_read_b64_tr_b16 v[50:51], v10 offset:2560
    ds_read_b64_tr_b16 v[52:53], v11 offset:2048
    ds_read_b64_tr_b16 v[54:55], v11 offset:2560
    ds_read_b128 v[28:31], v4 offset:2048
    ds_read_b128 v[32:35], v4 offset:4096
    ds_read_b128 v[36:39], v4 offset:6144
    s_waitcnt lgkmcnt(2)
    v_mfma_f32_16x16x32_bf16 v[88:91], v[40:43], v[24:27], 0
    ds_read_b128 v[56:59], v5 offset:0
    v_mfma_f32_16x16x32_bf16 v[92:95], v[44:47], v[24:27], 0
    ds_read_b64_tr_b16 v[72:73], v10 offset:8192
    v_mfma_f32_16x16x32_bf16 v[96:99], v[48:51], v[24:27], 0
    ds_read_b64_tr_b16 v[74:75], v10 offset:8704
    v_mfma_f32_16x16x32_bf16 v[100:103], v[52:55], v[24:27], 0
    ds_read_b64_tr_b16 v[76:77], v11 offset:8192
    v_mfma_f32_16x16x32_bf16 v[116:119], v[52:55], v[28:31], 0
    ds_read_b64_tr_b16 v[78:79], v11 offset:8704
    v_mfma_f32_16x16x32_bf16 v[112:115], v[48:51], v[28:31], 0
    ds_read_b64_tr_b16 v[80:81], v10 offset:10240
    v_mfma_f32_16x16x32_bf16 v[108:111], v[44:47], v[28:31], 0
    ds_read_b64_tr_b16 v[82:83], v10 offset:10752
    v_mfma_f32_16x16x32_bf16 v[104:107], v[40:43], v[28:31], 0
    ds_read_b64_tr_b16 v[84:85], v11 offset:10240
    s_waitcnt lgkmcnt(8)
    v_mfma_f32_16x16x32_bf16 v[120:123], v[40:43], v[32:35], 0
    ds_read_b64_tr_b16 v[86:87], v11 offset:10752
    v_mfma_f32_16x16x32_bf16 v[124:127], v[44:47], v[32:35], 0
    ds_read_b128 v[60:63], v5 offset:2048
    v_mfma_f32_16x16x32_bf16 v[128:131], v[48:51], v[32:35], 0
    ds_read_b128 v[64:67], v5 offset:4096
    v_mfma_f32_16x16x32_bf16 v[132:135], v[52:55], v[32:35], 0
    ds_read_b128 v[68:71], v5 offset:6144
    v_mfma_f32_16x16x32_bf16 v[148:151], v[52:55], v[36:39], 0
    v_mfma_f32_16x16x32_bf16 v[144:147], v[48:51], v[36:39], 0
    v_mfma_f32_16x16x32_bf16 v[140:143], v[44:47], v[36:39], 0
    v_mfma_f32_16x16x32_bf16 v[136:139], v[40:43], v[36:39], 0
    s_waitcnt lgkmcnt(2)
    v_mfma_f32_16x16x32_bf16 v[88:91], v[72:75], v[56:59], v[88:91]
    v_mfma_f32_16x16x32_bf16 v[92:95], v[76:79], v[56:59], v[92:95]
    v_mfma_f32_16x16x32_bf16 v[96:99], v[80:83], v[56:59], v[96:99]
    v_mfma_f32_16x16x32_bf16 v[100:103], v[84:87], v[56:59], v[100:103]
    v_mfma_f32_16x16x32_bf16 v[116:119], v[84:87], v[60:63], v[116:119]
    v_mfma_f32_16x16x32_bf16 v[112:115], v[80:83], v[60:63], v[112:115]
    v_mfma_f32_16x16x32_bf16 v[108:111], v[76:79], v[60:63], v[108:111]
    v_mfma_f32_16x16x32_bf16 v[104:107], v[72:75], v[60:63], v[104:107]
    s_waitcnt lgkmcnt(0)
    s_barrier
    v_mfma_f32_16x16x32_bf16 v[120:123], v[72:75], v[64:67], v[120:123]
    ds_read_b128 v[24:27], v4 offset:32768
    ds_read_b64_tr_b16 v[40:41], v10 offset:32768
    ds_read_b64_tr_b16 v[42:43], v10 offset:33280
    v_mfma_f32_16x16x32_bf16 v[124:127], v[76:79], v[64:67], v[124:127]
    ds_read_b64_tr_b16 v[44:45], v11 offset:32768
    ds_read_b64_tr_b16 v[46:47], v11 offset:33280
    ds_read_b64_tr_b16 v[48:49], v10 offset:34816
    v_mfma_f32_16x16x32_bf16 v[128:131], v[80:83], v[64:67], v[128:131]
    ds_read_b64_tr_b16 v[50:51], v10 offset:35328
    ds_read_b64_tr_b16 v[52:53], v11 offset:34816
    v_mfma_f32_16x16x32_bf16 v[132:135], v[84:87], v[64:67], v[132:135]
    ds_read_b64_tr_b16 v[54:55], v11 offset:35328
    ds_read_b128 v[28:31], v4 offset:34816
    v_mfma_f32_16x16x32_bf16 v[148:151], v[84:87], v[68:71], v[148:151]
    ds_read_b128 v[32:35], v4 offset:36864
    v_mfma_f32_16x16x32_bf16 v[144:147], v[80:83], v[68:71], v[144:147]
    ds_read_b128 v[36:39], v4 offset:38912
    v_mfma_f32_16x16x32_bf16 v[140:143], v[76:79], v[68:71], v[140:143]
    v_mfma_f32_16x16x32_bf16 v[136:139], v[72:75], v[68:71], v[136:139]
    ds_read_b128 v[56:59], v5 offset:32768
    s_waitcnt lgkmcnt(3)
    v_mfma_f32_16x16x32_bf16 v[88:91], v[40:43], v[24:27], v[88:91]
    ds_read_b64_tr_b16 v[72:73], v10 offset:40960
    v_mfma_f32_16x16x32_bf16 v[92:95], v[44:47], v[24:27], v[92:95]
    ds_read_b64_tr_b16 v[74:75], v10 offset:41472
    v_mfma_f32_16x16x32_bf16 v[96:99], v[48:51], v[24:27], v[96:99]
    ds_read_b64_tr_b16 v[76:77], v11 offset:40960
    v_mfma_f32_16x16x32_bf16 v[100:103], v[52:55], v[24:27], v[100:103]
    ds_read_b64_tr_b16 v[78:79], v11 offset:41472
    v_mfma_f32_16x16x32_bf16 v[116:119], v[52:55], v[28:31], v[116:119]
    ds_read_b64_tr_b16 v[80:81], v10 offset:43008
    v_mfma_f32_16x16x32_bf16 v[112:115], v[48:51], v[28:31], v[112:115]
    ds_read_b64_tr_b16 v[82:83], v10 offset:43520
    v_mfma_f32_16x16x32_bf16 v[108:111], v[44:47], v[28:31], v[108:111]
    ds_read_b64_tr_b16 v[84:85], v11 offset:43008
    v_mfma_f32_16x16x32_bf16 v[104:107], v[40:43], v[28:31], v[104:107]
    ds_read_b64_tr_b16 v[86:87], v11 offset:43520
    s_waitcnt lgkmcnt(9)
    v_mfma_f32_16x16x32_bf16 v[120:123], v[40:43], v[32:35], v[120:123]
    ds_read_b128 v[60:63], v5 offset:34816
    v_mfma_f32_16x16x32_bf16 v[124:127], v[44:47], v[32:35], v[124:127]
    ds_read_b128 v[64:67], v5 offset:36864
    v_mfma_f32_16x16x32_bf16 v[128:131], v[48:51], v[32:35], v[128:131]
    ds_read_b128 v[68:71], v5 offset:38912
    v_mfma_f32_16x16x32_bf16 v[132:135], v[52:55], v[32:35], v[132:135]
    v_mfma_f32_16x16x32_bf16 v[148:151], v[52:55], v[36:39], v[148:151]
    v_mfma_f32_16x16x32_bf16 v[144:147], v[48:51], v[36:39], v[144:147]
    v_mfma_f32_16x16x32_bf16 v[140:143], v[44:47], v[36:39], v[140:143]
    v_mfma_f32_16x16x32_bf16 v[136:139], v[40:43], v[36:39], v[136:139]
    s_waitcnt lgkmcnt(2)
    v_mfma_f32_16x16x32_bf16 v[88:91], v[72:75], v[56:59], v[88:91]
    v_mfma_f32_16x16x32_bf16 v[92:95], v[76:79], v[56:59], v[92:95]
    v_mfma_f32_16x16x32_bf16 v[96:99], v[80:83], v[56:59], v[96:99]
    v_mfma_f32_16x16x32_bf16 v[100:103], v[84:87], v[56:59], v[100:103]
    v_mfma_f32_16x16x32_bf16 v[116:119], v[84:87], v[60:63], v[116:119]
    v_mfma_f32_16x16x32_bf16 v[112:115], v[80:83], v[60:63], v[112:115]
    v_mfma_f32_16x16x32_bf16 v[108:111], v[76:79], v[60:63], v[108:111]
    v_mfma_f32_16x16x32_bf16 v[104:107], v[72:75], v[60:63], v[104:107]
    s_waitcnt lgkmcnt(0)
    s_barrier
    v_mfma_f32_16x16x32_bf16 v[120:123], v[72:75], v[64:67], v[120:123]
    ds_read_b128 v[24:27], v6 offset:0
    ds_read_b64_tr_b16 v[40:41], v12 offset:0
    ds_read_b64_tr_b16 v[42:43], v12 offset:512
    v_mfma_f32_16x16x32_bf16 v[124:127], v[76:79], v[64:67], v[124:127]
    ds_read_b64_tr_b16 v[44:45], v13 offset:0
    ds_read_b64_tr_b16 v[46:47], v13 offset:512
    ds_read_b64_tr_b16 v[48:49], v12 offset:2048
    v_mfma_f32_16x16x32_bf16 v[128:131], v[80:83], v[64:67], v[128:131]
    ds_read_b64_tr_b16 v[50:51], v12 offset:2560
    ds_read_b64_tr_b16 v[52:53], v13 offset:2048
    v_mfma_f32_16x16x32_bf16 v[132:135], v[84:87], v[64:67], v[132:135]
    ds_read_b64_tr_b16 v[54:55], v13 offset:2560
    ds_read_b128 v[28:31], v6 offset:2048
    v_mfma_f32_16x16x32_bf16 v[148:151], v[84:87], v[68:71], v[148:151]
    ds_read_b128 v[32:35], v6 offset:4096
    v_mfma_f32_16x16x32_bf16 v[144:147], v[80:83], v[68:71], v[144:147]
    ds_read_b128 v[36:39], v6 offset:6144
    v_mfma_f32_16x16x32_bf16 v[140:143], v[76:79], v[68:71], v[140:143]
    v_mfma_f32_16x16x32_bf16 v[136:139], v[72:75], v[68:71], v[136:139]
    ds_read_b128 v[56:59], v7 offset:0
    s_waitcnt lgkmcnt(3)
    v_mfma_f32_16x16x32_bf16 v[88:91], v[40:43], v[24:27], v[88:91]
    ds_read_b64_tr_b16 v[72:73], v12 offset:8192
    v_mfma_f32_16x16x32_bf16 v[92:95], v[44:47], v[24:27], v[92:95]
    ds_read_b64_tr_b16 v[74:75], v12 offset:8704
    v_mfma_f32_16x16x32_bf16 v[96:99], v[48:51], v[24:27], v[96:99]
    ds_read_b64_tr_b16 v[76:77], v13 offset:8192
    v_mfma_f32_16x16x32_bf16 v[100:103], v[52:55], v[24:27], v[100:103]
    ds_read_b64_tr_b16 v[78:79], v13 offset:8704
    v_mfma_f32_16x16x32_bf16 v[116:119], v[52:55], v[28:31], v[116:119]
    ds_read_b64_tr_b16 v[80:81], v12 offset:10240
    v_mfma_f32_16x16x32_bf16 v[112:115], v[48:51], v[28:31], v[112:115]
    ds_read_b64_tr_b16 v[82:83], v12 offset:10752
    v_mfma_f32_16x16x32_bf16 v[108:111], v[44:47], v[28:31], v[108:111]
    ds_read_b64_tr_b16 v[84:85], v13 offset:10240
    v_mfma_f32_16x16x32_bf16 v[104:107], v[40:43], v[28:31], v[104:107]
    ds_read_b64_tr_b16 v[86:87], v13 offset:10752
    s_waitcnt lgkmcnt(9)
    v_mfma_f32_16x16x32_bf16 v[120:123], v[40:43], v[32:35], v[120:123]
    ds_read_b128 v[60:63], v7 offset:2048
    v_mfma_f32_16x16x32_bf16 v[124:127], v[44:47], v[32:35], v[124:127]
    ds_read_b128 v[64:67], v7 offset:4096
    v_mfma_f32_16x16x32_bf16 v[128:131], v[48:51], v[32:35], v[128:131]
    ds_read_b128 v[68:71], v7 offset:6144
    v_mfma_f32_16x16x32_bf16 v[132:135], v[52:55], v[32:35], v[132:135]
    v_mfma_f32_16x16x32_bf16 v[148:151], v[52:55], v[36:39], v[148:151]
    v_mfma_f32_16x16x32_bf16 v[144:147], v[48:51], v[36:39], v[144:147]
    v_mfma_f32_16x16x32_bf16 v[140:143], v[44:47], v[36:39], v[140:143]
    v_mfma_f32_16x16x32_bf16 v[136:139], v[40:43], v[36:39], v[136:139]
    s_waitcnt lgkmcnt(2)
    v_mfma_f32_16x16x32_bf16 v[88:91], v[72:75], v[56:59], v[88:91]
    v_mfma_f32_16x16x32_bf16 v[92:95], v[76:79], v[56:59], v[92:95]
    v_mfma_f32_16x16x32_bf16 v[96:99], v[80:83], v[56:59], v[96:99]
    v_mfma_f32_16x16x32_bf16 v[100:103], v[84:87], v[56:59], v[100:103]
    v_mfma_f32_16x16x32_bf16 v[116:119], v[84:87], v[60:63], v[116:119]
    v_mfma_f32_16x16x32_bf16 v[112:115], v[80:83], v[60:63], v[112:115]
    v_mfma_f32_16x16x32_bf16 v[108:111], v[76:79], v[60:63], v[108:111]
    v_mfma_f32_16x16x32_bf16 v[104:107], v[72:75], v[60:63], v[104:107]
    s_waitcnt lgkmcnt(0)
    s_barrier
    v_mfma_f32_16x16x32_bf16 v[120:123], v[72:75], v[64:67], v[120:123]
    ds_read_b128 v[24:27], v6 offset:32768
    ds_read_b64_tr_b16 v[40:41], v12 offset:32768
    ds_read_b64_tr_b16 v[42:43], v12 offset:33280
    v_mfma_f32_16x16x32_bf16 v[124:127], v[76:79], v[64:67], v[124:127]
    ds_read_b64_tr_b16 v[44:45], v13 offset:32768
    ds_read_b64_tr_b16 v[46:47], v13 offset:33280
    ds_read_b64_tr_b16 v[48:49], v12 offset:34816
    v_mfma_f32_16x16x32_bf16 v[128:131], v[80:83], v[64:67], v[128:131]
    ds_read_b64_tr_b16 v[50:51], v12 offset:35328
    ds_read_b64_tr_b16 v[52:53], v13 offset:34816
    v_mfma_f32_16x16x32_bf16 v[132:135], v[84:87], v[64:67], v[132:135]
    ds_read_b64_tr_b16 v[54:55], v13 offset:35328
    ds_read_b128 v[28:31], v6 offset:34816
    v_mfma_f32_16x16x32_bf16 v[148:151], v[84:87], v[68:71], v[148:151]
    ds_read_b128 v[32:35], v6 offset:36864
    v_mfma_f32_16x16x32_bf16 v[144:147], v[80:83], v[68:71], v[144:147]
    ds_read_b128 v[36:39], v6 offset:38912
    v_mfma_f32_16x16x32_bf16 v[140:143], v[76:79], v[68:71], v[140:143]
    v_mfma_f32_16x16x32_bf16 v[136:139], v[72:75], v[68:71], v[136:139]
    ds_read_b128 v[56:59], v7 offset:32768
    s_waitcnt lgkmcnt(3)
    v_mfma_f32_16x16x32_bf16 v[88:91], v[40:43], v[24:27], v[88:91]
    ds_read_b64_tr_b16 v[72:73], v12 offset:40960
    v_mfma_f32_16x16x32_bf16 v[92:95], v[44:47], v[24:27], v[92:95]
    ds_read_b64_tr_b16 v[74:75], v12 offset:41472
    v_mfma_f32_16x16x32_bf16 v[96:99], v[48:51], v[24:27], v[96:99]
    ds_read_b64_tr_b16 v[76:77], v13 offset:40960
    v_mfma_f32_16x16x32_bf16 v[100:103], v[52:55], v[24:27], v[100:103]
    ds_read_b64_tr_b16 v[78:79], v13 offset:41472
    v_mfma_f32_16x16x32_bf16 v[116:119], v[52:55], v[28:31], v[116:119]
    ds_read_b64_tr_b16 v[80:81], v12 offset:43008
    v_mfma_f32_16x16x32_bf16 v[112:115], v[48:51], v[28:31], v[112:115]
    ds_read_b64_tr_b16 v[82:83], v12 offset:43520
    v_mfma_f32_16x16x32_bf16 v[108:111], v[44:47], v[28:31], v[108:111]
    ds_read_b64_tr_b16 v[84:85], v13 offset:43008
    v_mfma_f32_16x16x32_bf16 v[104:107], v[40:43], v[28:31], v[104:107]
    ds_read_b64_tr_b16 v[86:87], v13 offset:43520
    s_waitcnt lgkmcnt(9)
    v_mfma_f32_16x16x32_bf16 v[120:123], v[40:43], v[32:35], v[120:123]
    ds_read_b128 v[60:63], v7 offset:34816
    v_mfma_f32_16x16x32_bf16 v[124:127], v[44:47], v[32:35], v[124:127]
    ds_read_b128 v[64:67], v7 offset:36864
    v_mfma_f32_16x16x32_bf16 v[128:131], v[48:51], v[32:35], v[128:131]
    ds_read_b128 v[68:71], v7 offset:38912
    v_mfma_f32_16x16x32_bf16 v[132:135], v[52:55], v[32:35], v[132:135]
    v_mfma_f32_16x16x32_bf16 v[148:151], v[52:55], v[36:39], v[148:151]
    v_mfma_f32_16x16x32_bf16 v[144:147], v[48:51], v[36:39], v[144:147]
    v_mfma_f32_16x16x32_bf16 v[140:143], v[44:47], v[36:39], v[140:143]
    v_mfma_f32_16x16x32_bf16 v[136:139], v[40:43], v[36:39], v[136:139]
    s_waitcnt lgkmcnt(2)
    v_mfma_f32_16x16x32_bf16 v[88:91], v[72:75], v[56:59], v[88:91]
    v_mfma_f32_16x16x32_bf16 v[92:95], v[76:79], v[56:59], v[92:95]
    v_mfma_f32_16x16x32_bf16 v[96:99], v[80:83], v[56:59], v[96:99]
    v_mfma_f32_16x16x32_bf16 v[100:103], v[84:87], v[56:59], v[100:103]
    v_mfma_f32_16x16x32_bf16 v[116:119], v[84:87], v[60:63], v[116:119]
    v_mfma_f32_16x16x32_bf16 v[112:115], v[80:83], v[60:63], v[112:115]
    v_mfma_f32_16x16x32_bf16 v[108:111], v[76:79], v[60:63], v[108:111]
    v_mfma_f32_16x16x32_bf16 v[104:107], v[72:75], v[60:63], v[104:107]
    s_waitcnt lgkmcnt(0)
    s_barrier
    v_mfma_f32_16x16x32_bf16 v[120:123], v[72:75], v[64:67], v[120:123]
    ds_read_b128 v[24:27], v8 offset:0
    ds_read_b64_tr_b16 v[40:41], v14 offset:0
    ds_read_b64_tr_b16 v[42:43], v14 offset:512
    v_mfma_f32_16x16x32_bf16 v[124:127], v[76:79], v[64:67], v[124:127]
    ds_read_b64_tr_b16 v[44:45], v15 offset:0
    ds_read_b64_tr_b16 v[46:47], v15 offset:512
    ds_read_b64_tr_b16 v[48:49], v14 offset:2048
    v_mfma_f32_16x16x32_bf16 v[128:131], v[80:83], v[64:67], v[128:131]
    ds_read_b64_tr_b16 v[50:51], v14 offset:2560
    ds_read_b64_tr_b16 v[52:53], v15 offset:2048
    v_mfma_f32_16x16x32_bf16 v[132:135], v[84:87], v[64:67], v[132:135]
    ds_read_b64_tr_b16 v[54:55], v15 offset:2560
    ds_read_b128 v[28:31], v8 offset:2048
    v_mfma_f32_16x16x32_bf16 v[148:151], v[84:87], v[68:71], v[148:151]
    ds_read_b128 v[32:35], v8 offset:4096
    v_mfma_f32_16x16x32_bf16 v[144:147], v[80:83], v[68:71], v[144:147]
    ds_read_b128 v[36:39], v8 offset:6144
    v_mfma_f32_16x16x32_bf16 v[140:143], v[76:79], v[68:71], v[140:143]
    v_mfma_f32_16x16x32_bf16 v[136:139], v[72:75], v[68:71], v[136:139]
    ds_read_b128 v[56:59], v9 offset:0
    s_waitcnt lgkmcnt(3)
    v_mfma_f32_16x16x32_bf16 v[88:91], v[40:43], v[24:27], v[88:91]
    ds_read_b64_tr_b16 v[72:73], v14 offset:8192
    v_mfma_f32_16x16x32_bf16 v[92:95], v[44:47], v[24:27], v[92:95]
    ds_read_b64_tr_b16 v[74:75], v14 offset:8704
    v_mfma_f32_16x16x32_bf16 v[96:99], v[48:51], v[24:27], v[96:99]
    ds_read_b64_tr_b16 v[76:77], v15 offset:8192
    v_mfma_f32_16x16x32_bf16 v[100:103], v[52:55], v[24:27], v[100:103]
    ds_read_b64_tr_b16 v[78:79], v15 offset:8704
    v_mfma_f32_16x16x32_bf16 v[116:119], v[52:55], v[28:31], v[116:119]
    ds_read_b64_tr_b16 v[80:81], v14 offset:10240
    v_mfma_f32_16x16x32_bf16 v[112:115], v[48:51], v[28:31], v[112:115]
    ds_read_b64_tr_b16 v[82:83], v14 offset:10752
    v_mfma_f32_16x16x32_bf16 v[108:111], v[44:47], v[28:31], v[108:111]
    ds_read_b64_tr_b16 v[84:85], v15 offset:10240
    v_mfma_f32_16x16x32_bf16 v[104:107], v[40:43], v[28:31], v[104:107]
    ds_read_b64_tr_b16 v[86:87], v15 offset:10752
    s_waitcnt lgkmcnt(9)
    v_mfma_f32_16x16x32_bf16 v[120:123], v[40:43], v[32:35], v[120:123]
    ds_read_b128 v[60:63], v9 offset:2048
    v_mfma_f32_16x16x32_bf16 v[124:127], v[44:47], v[32:35], v[124:127]
    ds_read_b128 v[64:67], v9 offset:4096
    v_mfma_f32_16x16x32_bf16 v[128:131], v[48:51], v[32:35], v[128:131]
    ds_read_b128 v[68:71], v9 offset:6144
    v_mfma_f32_16x16x32_bf16 v[132:135], v[52:55], v[32:35], v[132:135]
    v_mfma_f32_16x16x32_bf16 v[148:151], v[52:55], v[36:39], v[148:151]
    v_mfma_f32_16x16x32_bf16 v[144:147], v[48:51], v[36:39], v[144:147]
    v_mfma_f32_16x16x32_bf16 v[140:143], v[44:47], v[36:39], v[140:143]
    v_mfma_f32_16x16x32_bf16 v[136:139], v[40:43], v[36:39], v[136:139]
    s_waitcnt lgkmcnt(2)
    v_mfma_f32_16x16x32_bf16 v[88:91], v[72:75], v[56:59], v[88:91]
    v_mfma_f32_16x16x32_bf16 v[92:95], v[76:79], v[56:59], v[92:95]
    v_mfma_f32_16x16x32_bf16 v[96:99], v[80:83], v[56:59], v[96:99]
    v_mfma_f32_16x16x32_bf16 v[100:103], v[84:87], v[56:59], v[100:103]
    v_mfma_f32_16x16x32_bf16 v[116:119], v[84:87], v[60:63], v[116:119]
    v_mfma_f32_16x16x32_bf16 v[112:115], v[80:83], v[60:63], v[112:115]
    v_mfma_f32_16x16x32_bf16 v[108:111], v[76:79], v[60:63], v[108:111]
    v_mfma_f32_16x16x32_bf16 v[104:107], v[72:75], v[60:63], v[104:107]
    s_waitcnt lgkmcnt(0)
    s_barrier
    v_mfma_f32_16x16x32_bf16 v[120:123], v[72:75], v[64:67], v[120:123]
    ds_read_b128 v[24:27], v4 offset:0
    ds_read_b64_tr_b16 v[40:41], v10 offset:0
    ds_read_b64_tr_b16 v[42:43], v10 offset:512
    v_mfma_f32_16x16x32_bf16 v[124:127], v[76:79], v[64:67], v[124:127]
    ds_read_b64_tr_b16 v[44:45], v11 offset:0
    ds_read_b64_tr_b16 v[46:47], v11 offset:512
    ds_read_b64_tr_b16 v[48:49], v10 offset:2048
    v_mfma_f32_16x16x32_bf16 v[128:131], v[80:83], v[64:67], v[128:131]
    ds_read_b64_tr_b16 v[50:51], v10 offset:2560
    ds_read_b64_tr_b16 v[52:53], v11 offset:2048
    v_mfma_f32_16x16x32_bf16 v[132:135], v[84:87], v[64:67], v[132:135]
    ds_read_b64_tr_b16 v[54:55], v11 offset:2560
    ds_read_b128 v[28:31], v4 offset:2048
    v_mfma_f32_16x16x32_bf16 v[148:151], v[84:87], v[68:71], v[148:151]
    ds_read_b128 v[32:35], v4 offset:4096
    v_mfma_f32_16x16x32_bf16 v[144:147], v[80:83], v[68:71], v[144:147]
    ds_read_b128 v[36:39], v4 offset:6144
    v_mfma_f32_16x16x32_bf16 v[140:143], v[76:79], v[68:71], v[140:143]
    v_mfma_f32_16x16x32_bf16 v[136:139], v[72:75], v[68:71], v[136:139]
    ds_read_b128 v[56:59], v5 offset:0
    s_waitcnt lgkmcnt(3)
    v_mfma_f32_16x16x32_bf16 v[88:91], v[40:43], v[24:27], v[88:91]
    ds_read_b64_tr_b16 v[72:73], v10 offset:8192
    v_mfma_f32_16x16x32_bf16 v[92:95], v[44:47], v[24:27], v[92:95]
    ds_read_b64_tr_b16 v[74:75], v10 offset:8704
    v_mfma_f32_16x16x32_bf16 v[96:99], v[48:51], v[24:27], v[96:99]
    ds_read_b64_tr_b16 v[76:77], v11 offset:8192
    v_mfma_f32_16x16x32_bf16 v[100:103], v[52:55], v[24:27], v[100:103]
    ds_read_b64_tr_b16 v[78:79], v11 offset:8704
    v_mfma_f32_16x16x32_bf16 v[116:119], v[52:55], v[28:31], v[116:119]
    ds_read_b64_tr_b16 v[80:81], v10 offset:10240
    v_mfma_f32_16x16x32_bf16 v[112:115], v[48:51], v[28:31], v[112:115]
    ds_read_b64_tr_b16 v[82:83], v10 offset:10752
    v_mfma_f32_16x16x32_bf16 v[108:111], v[44:47], v[28:31], v[108:111]
    ds_read_b64_tr_b16 v[84:85], v11 offset:10240
    v_mfma_f32_16x16x32_bf16 v[104:107], v[40:43], v[28:31], v[104:107]
    ds_read_b64_tr_b16 v[86:87], v11 offset:10752
    s_waitcnt lgkmcnt(9)
    v_mfma_f32_16x16x32_bf16 v[120:123], v[40:43], v[32:35], v[120:123]
    ds_read_b128 v[60:63], v5 offset:2048
    v_mfma_f32_16x16x32_bf16 v[124:127], v[44:47], v[32:35], v[124:127]
    ds_read_b128 v[64:67], v5 offset:4096
    v_mfma_f32_16x16x32_bf16 v[128:131], v[48:51], v[32:35], v[128:131]
    ds_read_b128 v[68:71], v5 offset:6144
    v_mfma_f32_16x16x32_bf16 v[132:135], v[52:55], v[32:35], v[132:135]
    v_mfma_f32_16x16x32_bf16 v[148:151], v[52:55], v[36:39], v[148:151]
    v_mfma_f32_16x16x32_bf16 v[144:147], v[48:51], v[36:39], v[144:147]
    v_mfma_f32_16x16x32_bf16 v[140:143], v[44:47], v[36:39], v[140:143]
    v_mfma_f32_16x16x32_bf16 v[136:139], v[40:43], v[36:39], v[136:139]
    s_waitcnt lgkmcnt(2)
    v_mfma_f32_16x16x32_bf16 v[88:91], v[72:75], v[56:59], v[88:91]
    v_mfma_f32_16x16x32_bf16 v[92:95], v[76:79], v[56:59], v[92:95]
    v_mfma_f32_16x16x32_bf16 v[96:99], v[80:83], v[56:59], v[96:99]
    v_mfma_f32_16x16x32_bf16 v[100:103], v[84:87], v[56:59], v[100:103]
    v_mfma_f32_16x16x32_bf16 v[116:119], v[84:87], v[60:63], v[116:119]
    v_mfma_f32_16x16x32_bf16 v[112:115], v[80:83], v[60:63], v[112:115]
    v_mfma_f32_16x16x32_bf16 v[108:111], v[76:79], v[60:63], v[108:111]
    v_mfma_f32_16x16x32_bf16 v[104:107], v[72:75], v[60:63], v[104:107]
    s_waitcnt lgkmcnt(0)
    s_barrier
    v_mfma_f32_16x16x32_bf16 v[120:123], v[72:75], v[64:67], v[120:123]
    ds_read_b128 v[24:27], v4 offset:32768
    ds_read_b64_tr_b16 v[40:41], v10 offset:32768
    ds_read_b64_tr_b16 v[42:43], v10 offset:33280
    v_mfma_f32_16x16x32_bf16 v[124:127], v[76:79], v[64:67], v[124:127]
    ds_read_b64_tr_b16 v[44:45], v11 offset:32768
    ds_read_b64_tr_b16 v[46:47], v11 offset:33280
    ds_read_b64_tr_b16 v[48:49], v10 offset:34816
    v_mfma_f32_16x16x32_bf16 v[128:131], v[80:83], v[64:67], v[128:131]
    ds_read_b64_tr_b16 v[50:51], v10 offset:35328
    ds_read_b64_tr_b16 v[52:53], v11 offset:34816
    v_mfma_f32_16x16x32_bf16 v[132:135], v[84:87], v[64:67], v[132:135]
    ds_read_b64_tr_b16 v[54:55], v11 offset:35328
    ds_read_b128 v[28:31], v4 offset:34816
    v_mfma_f32_16x16x32_bf16 v[148:151], v[84:87], v[68:71], v[148:151]
    ds_read_b128 v[32:35], v4 offset:36864
    v_mfma_f32_16x16x32_bf16 v[144:147], v[80:83], v[68:71], v[144:147]
    ds_read_b128 v[36:39], v4 offset:38912
    v_mfma_f32_16x16x32_bf16 v[140:143], v[76:79], v[68:71], v[140:143]
    v_mfma_f32_16x16x32_bf16 v[136:139], v[72:75], v[68:71], v[136:139]
    ds_read_b128 v[56:59], v5 offset:32768
    s_waitcnt lgkmcnt(3)
    v_mfma_f32_16x16x32_bf16 v[88:91], v[40:43], v[24:27], v[88:91]
    ds_read_b64_tr_b16 v[72:73], v10 offset:40960
    v_mfma_f32_16x16x32_bf16 v[92:95], v[44:47], v[24:27], v[92:95]
    ds_read_b64_tr_b16 v[74:75], v10 offset:41472
    v_mfma_f32_16x16x32_bf16 v[96:99], v[48:51], v[24:27], v[96:99]
    ds_read_b64_tr_b16 v[76:77], v11 offset:40960
    v_mfma_f32_16x16x32_bf16 v[100:103], v[52:55], v[24:27], v[100:103]
    ds_read_b64_tr_b16 v[78:79], v11 offset:41472
    v_mfma_f32_16x16x32_bf16 v[116:119], v[52:55], v[28:31], v[116:119]
    ds_read_b64_tr_b16 v[80:81], v10 offset:43008
    v_mfma_f32_16x16x32_bf16 v[112:115], v[48:51], v[28:31], v[112:115]
    ds_read_b64_tr_b16 v[82:83], v10 offset:43520
    v_mfma_f32_16x16x32_bf16 v[108:111], v[44:47], v[28:31], v[108:111]
    ds_read_b64_tr_b16 v[84:85], v11 offset:43008
    v_mfma_f32_16x16x32_bf16 v[104:107], v[40:43], v[28:31], v[104:107]
    ds_read_b64_tr_b16 v[86:87], v11 offset:43520
    s_waitcnt lgkmcnt(9)
    v_mfma_f32_16x16x32_bf16 v[120:123], v[40:43], v[32:35], v[120:123]
    ds_read_b128 v[60:63], v5 offset:34816
    v_mfma_f32_16x16x32_bf16 v[124:127], v[44:47], v[32:35], v[124:127]
    ds_read_b128 v[64:67], v5 offset:36864
    v_mfma_f32_16x16x32_bf16 v[128:131], v[48:51], v[32:35], v[128:131]
    ds_read_b128 v[68:71], v5 offset:38912
    v_mfma_f32_16x16x32_bf16 v[132:135], v[52:55], v[32:35], v[132:135]
    v_mfma_f32_16x16x32_bf16 v[148:151], v[52:55], v[36:39], v[148:151]
    v_mfma_f32_16x16x32_bf16 v[144:147], v[48:51], v[36:39], v[144:147]
    v_mfma_f32_16x16x32_bf16 v[140:143], v[44:47], v[36:39], v[140:143]
    v_mfma_f32_16x16x32_bf16 v[136:139], v[40:43], v[36:39], v[136:139]
    s_waitcnt lgkmcnt(2)
    v_mfma_f32_16x16x32_bf16 v[88:91], v[72:75], v[56:59], v[88:91]
    v_mfma_f32_16x16x32_bf16 v[92:95], v[76:79], v[56:59], v[92:95]
    v_mfma_f32_16x16x32_bf16 v[96:99], v[80:83], v[56:59], v[96:99]
    v_mfma_f32_16x16x32_bf16 v[100:103], v[84:87], v[56:59], v[100:103]
    v_mfma_f32_16x16x32_bf16 v[116:119], v[84:87], v[60:63], v[116:119]
    v_mfma_f32_16x16x32_bf16 v[112:115], v[80:83], v[60:63], v[112:115]
    v_mfma_f32_16x16x32_bf16 v[108:111], v[76:79], v[60:63], v[108:111]
    v_mfma_f32_16x16x32_bf16 v[104:107], v[72:75], v[60:63], v[104:107]
    s_waitcnt lgkmcnt(0)
    s_barrier
    v_mfma_f32_16x16x32_bf16 v[120:123], v[72:75], v[64:67], v[120:123]
    ds_read_b128 v[24:27], v6 offset:0
    ds_read_b64_tr_b16 v[40:41], v12 offset:0
    ds_read_b64_tr_b16 v[42:43], v12 offset:512
    v_mfma_f32_16x16x32_bf16 v[124:127], v[76:79], v[64:67], v[124:127]
    ds_read_b64_tr_b16 v[44:45], v13 offset:0
    ds_read_b64_tr_b16 v[46:47], v13 offset:512
    ds_read_b64_tr_b16 v[48:49], v12 offset:2048
    v_mfma_f32_16x16x32_bf16 v[128:131], v[80:83], v[64:67], v[128:131]
    ds_read_b64_tr_b16 v[50:51], v12 offset:2560
    ds_read_b64_tr_b16 v[52:53], v13 offset:2048
    v_mfma_f32_16x16x32_bf16 v[132:135], v[84:87], v[64:67], v[132:135]
    ds_read_b64_tr_b16 v[54:55], v13 offset:2560
    ds_read_b128 v[28:31], v6 offset:2048
    v_mfma_f32_16x16x32_bf16 v[148:151], v[84:87], v[68:71], v[148:151]
    v_mfma_f32_16x16x32_bf16 v[144:147], v[80:83], v[68:71], v[144:147]
    v_mfma_f32_16x16x32_bf16 v[140:143], v[76:79], v[68:71], v[140:143]
    v_mfma_f32_16x16x32_bf16 v[136:139], v[72:75], v[68:71], v[136:139]
    ds_read_b128 v[56:59], v7 offset:0
    s_waitcnt lgkmcnt(2)
    v_mfma_f32_16x16x32_bf16 v[88:91], v[40:43], v[24:27], v[88:91]
    ds_read_b64_tr_b16 v[72:73], v12 offset:8192
    ds_read_b64_tr_b16 v[74:75], v12 offset:8704
    v_mfma_f32_16x16x32_bf16 v[92:95], v[44:47], v[24:27], v[92:95]
    ds_read_b64_tr_b16 v[76:77], v13 offset:8192
    ds_read_b64_tr_b16 v[78:79], v13 offset:8704
    v_mfma_f32_16x16x32_bf16 v[96:99], v[48:51], v[24:27], v[96:99]
    ds_read_b64_tr_b16 v[80:81], v12 offset:10240
    ds_read_b64_tr_b16 v[82:83], v12 offset:10752
    v_mfma_f32_16x16x32_bf16 v[100:103], v[52:55], v[24:27], v[100:103]
    ds_read_b64_tr_b16 v[84:85], v13 offset:10240
    ds_read_b64_tr_b16 v[86:87], v13 offset:10752
    s_waitcnt lgkmcnt(0)
    v_mfma_f32_16x16x32_bf16 v[100:103], v[84:87], v[56:59], v[100:103]
    ds_read_b128 v[60:63], v7 offset:2048
    ds_read_b128 v[32:35], v6 offset:4096
    v_mfma_f32_16x16x32_bf16 v[96:99], v[80:83], v[56:59], v[96:99]
    ds_read_b128 v[36:39], v6 offset:6144
    ds_read_b128 v[64:67], v7 offset:4096
    v_mfma_f32_16x16x32_bf16 v[92:95], v[76:79], v[56:59], v[92:95]
    ds_read_b128 v[68:71], v7 offset:6144
    v_mfma_f32_16x16x32_bf16 v[88:91], v[72:75], v[56:59], v[88:91]
    s_waitcnt lgkmcnt(0)
    s_barrier
    s_setprio 3
    v_mfma_f32_16x16x32_bf16 v[104:107], v[40:43], v[28:31], v[104:107]
    v_mfma_f32_16x16x32_bf16 v[108:111], v[44:47], v[28:31], v[108:111]
    v_mfma_f32_16x16x32_bf16 v[112:115], v[48:51], v[28:31], v[112:115]
    v_mfma_f32_16x16x32_bf16 v[116:119], v[52:55], v[28:31], v[116:119]
    s_nop 1
    v_mfma_f32_16x16x32_bf16 v[116:119], v[84:87], v[60:63], v[116:119]
    v_pk_mul_f32 v[152:153], v[88:89], s[58:59]
    v_pk_mul_f32 v[154:155], v[90:91], s[58:59]
    v_mfma_f32_16x16x32_bf16 v[112:115], v[80:83], v[60:63], v[112:115]
    v_pk_mul_f32 v[156:157], v[92:93], s[58:59]
    v_pk_mul_f32 v[158:159], v[94:95], s[58:59]
    v_mfma_f32_16x16x32_bf16 v[108:111], v[76:79], v[60:63], v[108:111]
    v_exp_f32 v152, v152
    v_mfma_f32_16x16x32_bf16 v[104:107], v[72:75], v[60:63], v[104:107]
    v_exp_f32 v153, v153
    v_mfma_f32_16x16x32_bf16 v[120:123], v[40:43], v[32:35], v[120:123]
    v_exp_f32 v154, v154
    v_mfma_f32_16x16x32_bf16 v[124:127], v[44:47], v[32:35], v[124:127]
    v_exp_f32 v155, v155
    v_mfma_f32_16x16x32_bf16 v[128:131], v[48:51], v[32:35], v[128:131]
    v_exp_f32 v156, v156
    v_mfma_f32_16x16x32_bf16 v[132:135], v[52:55], v[32:35], v[132:135]
    v_exp_f32 v157, v157
    v_mfma_f32_16x16x32_bf16 v[132:135], v[84:87], v[64:67], v[132:135]
    v_exp_f32 v158, v158
    v_mfma_f32_16x16x32_bf16 v[128:131], v[80:83], v[64:67], v[128:131]
    v_exp_f32 v159, v159
    v_mfma_f32_16x16x32_bf16 v[124:127], v[76:79], v[64:67], v[124:127]
    v_pk_mul_f32 v[88:89], v[88:89], v[96:97]
    v_pk_mul_f32 v[90:91], v[90:91], v[98:99]
    v_mfma_f32_16x16x32_bf16 v[120:123], v[72:75], v[64:67], v[120:123]
    v_pk_mul_f32 v[92:93], v[92:93], v[100:101]
    v_pk_mul_f32 v[94:95], v[94:95], v[102:103]
    v_mfma_f32_16x16x32_bf16 v[136:139], v[40:43], v[36:39], v[136:139]
    v_pk_add_f32 v[152:153], v[152:153], s[60:61]
    v_pk_add_f32 v[154:155], v[154:155], s[60:61]
    v_mfma_f32_16x16x32_bf16 v[140:143], v[44:47], v[36:39], v[140:143]
    v_pk_add_f32 v[156:157], v[156:157], s[60:61]
    v_pk_add_f32 v[158:159], v[158:159], s[60:61]
    v_mfma_f32_16x16x32_bf16 v[144:147], v[48:51], v[36:39], v[144:147]
    v_rcp_f32 v152, v152
    v_mfma_f32_16x16x32_bf16 v[148:151], v[52:55], v[36:39], v[148:151]
    v_rcp_f32 v153, v153
    v_mfma_f32_16x16x32_bf16 v[148:151], v[84:87], v[68:71], v[148:151]
    v_rcp_f32 v154, v154
    v_mfma_f32_16x16x32_bf16 v[144:147], v[80:83], v[68:71], v[144:147]
    v_rcp_f32 v155, v155
    v_mfma_f32_16x16x32_bf16 v[140:143], v[76:79], v[68:71], v[140:143]
    v_rcp_f32 v156, v156
    v_mfma_f32_16x16x32_bf16 v[136:139], v[72:75], v[68:71], v[136:139]
    v_rcp_f32 v157, v157
    v_rcp_f32 v158, v158
    v_rcp_f32 v159, v159
    s_nop 0
    v_pk_mul_f32 v[88:89], v[88:89], v[152:153]
    v_pk_mul_f32 v[90:91], v[90:91], v[154:155]
    v_pk_mul_f32 v[92:93], v[92:93], v[156:157]
    v_pk_mul_f32 v[94:95], v[94:95], v[158:159]
    v_cvt_pk_bf16_f32 v160, v88, v89
    v_cvt_pk_bf16_f32 v161, v90, v91
    v_cvt_pk_bf16_f32 v162, v92, v93
    v_cvt_pk_bf16_f32 v163, v94, v95
    s_nop 1
    v_permlane16_swap_b32 v160, v162
    v_permlane16_swap_b32 v161, v163
    buffer_store_dwordx4 v[160:163], v22, s[36:39], s21 offen offset:0 sc1
    v_pk_mul_f32 v[164:165], v[104:105], s[58:59]
    v_pk_mul_f32 v[166:167], v[106:107], s[58:59]
    v_pk_mul_f32 v[168:169], v[108:109], s[58:59]
    v_pk_mul_f32 v[170:171], v[110:111], s[58:59]
    v_exp_f32 v164, v164
    v_exp_f32 v165, v165
    v_exp_f32 v166, v166
    v_exp_f32 v167, v167
    v_exp_f32 v168, v168
    v_exp_f32 v169, v169
    v_exp_f32 v170, v170
    v_exp_f32 v171, v171
    v_pk_mul_f32 v[104:105], v[104:105], v[112:113]
    v_pk_mul_f32 v[106:107], v[106:107], v[114:115]
    v_pk_mul_f32 v[108:109], v[108:109], v[116:117]
    v_pk_mul_f32 v[110:111], v[110:111], v[118:119]
    v_pk_add_f32 v[164:165], v[164:165], s[60:61]
    v_pk_add_f32 v[166:167], v[166:167], s[60:61]
    v_pk_add_f32 v[168:169], v[168:169], s[60:61]
    v_pk_add_f32 v[170:171], v[170:171], s[60:61]
    v_rcp_f32 v164, v164
    v_rcp_f32 v165, v165
    v_rcp_f32 v166, v166
    v_rcp_f32 v167, v167
    v_rcp_f32 v168, v168
    v_rcp_f32 v169, v169
    v_rcp_f32 v170, v170
    v_rcp_f32 v171, v171
    s_nop 0
    v_pk_mul_f32 v[104:105], v[104:105], v[164:165]
    v_pk_mul_f32 v[106:107], v[106:107], v[166:167]
    v_pk_mul_f32 v[108:109], v[108:109], v[168:169]
    v_pk_mul_f32 v[110:111], v[110:111], v[170:171]
    v_cvt_pk_bf16_f32 v172, v104, v105
    v_cvt_pk_bf16_f32 v173, v106, v107
    v_cvt_pk_bf16_f32 v174, v108, v109
    v_cvt_pk_bf16_f32 v175, v110, v111
    s_nop 1
    v_permlane16_swap_b32 v172, v174
    v_permlane16_swap_b32 v173, v175
    buffer_store_dwordx4 v[172:175], v22, s[36:39], s21 offen offset:1024 sc1
    v_pk_mul_f32 v[176:177], v[120:121], s[58:59]
    v_pk_mul_f32 v[178:179], v[122:123], s[58:59]
    v_pk_mul_f32 v[180:181], v[124:125], s[58:59]
    v_pk_mul_f32 v[182:183], v[126:127], s[58:59]
    v_exp_f32 v176, v176
    v_exp_f32 v177, v177
    v_exp_f32 v178, v178
    v_exp_f32 v179, v179
    v_exp_f32 v180, v180
    v_exp_f32 v181, v181
    v_exp_f32 v182, v182
    v_exp_f32 v183, v183
    v_pk_mul_f32 v[120:121], v[120:121], v[128:129]
    v_pk_mul_f32 v[122:123], v[122:123], v[130:131]
    v_pk_mul_f32 v[124:125], v[124:125], v[132:133]
    v_pk_mul_f32 v[126:127], v[126:127], v[134:135]
    v_pk_add_f32 v[176:177], v[176:177], s[60:61]
    v_pk_add_f32 v[178:179], v[178:179], s[60:61]
    v_pk_add_f32 v[180:181], v[180:181], s[60:61]
    v_pk_add_f32 v[182:183], v[182:183], s[60:61]
    v_rcp_f32 v176, v176
    v_rcp_f32 v177, v177
    v_rcp_f32 v178, v178
    v_rcp_f32 v179, v179
    v_rcp_f32 v180, v180
    v_rcp_f32 v181, v181
    v_rcp_f32 v182, v182
    v_rcp_f32 v183, v183
    s_nop 0
    v_pk_mul_f32 v[120:121], v[120:121], v[176:177]
    v_pk_mul_f32 v[122:123], v[122:123], v[178:179]
    v_pk_mul_f32 v[124:125], v[124:125], v[180:181]
    v_pk_mul_f32 v[126:127], v[126:127], v[182:183]
    v_cvt_pk_bf16_f32 v184, v120, v121
    v_cvt_pk_bf16_f32 v185, v122, v123
    v_cvt_pk_bf16_f32 v186, v124, v125
    v_cvt_pk_bf16_f32 v187, v126, v127
    s_nop 1
    v_permlane16_swap_b32 v184, v186
    v_permlane16_swap_b32 v185, v187
    buffer_store_dwordx4 v[184:187], v22, s[36:39], s22 offen offset:0 sc1
    v_pk_mul_f32 v[188:189], v[136:137], s[58:59]
    v_pk_mul_f32 v[190:191], v[138:139], s[58:59]
    v_pk_mul_f32 v[192:193], v[140:141], s[58:59]
    v_pk_mul_f32 v[194:195], v[142:143], s[58:59]
    v_exp_f32 v188, v188
    v_exp_f32 v189, v189
    v_exp_f32 v190, v190
    v_exp_f32 v191, v191
    v_exp_f32 v192, v192
    v_exp_f32 v193, v193
    v_exp_f32 v194, v194
    v_exp_f32 v195, v195
    v_pk_mul_f32 v[136:137], v[136:137], v[144:145]
    v_pk_mul_f32 v[138:139], v[138:139], v[146:147]
    v_pk_mul_f32 v[140:141], v[140:141], v[148:149]
    v_pk_mul_f32 v[142:143], v[142:143], v[150:151]
    v_pk_add_f32 v[188:189], v[188:189], s[60:61]
    v_pk_add_f32 v[190:191], v[190:191], s[60:61]
    v_pk_add_f32 v[192:193], v[192:193], s[60:61]
    v_pk_add_f32 v[194:195], v[194:195], s[60:61]
    v_rcp_f32 v188, v188
    v_rcp_f32 v189, v189
    v_rcp_f32 v190, v190
    v_rcp_f32 v191, v191
    v_rcp_f32 v192, v192
    v_rcp_f32 v193, v193
    v_rcp_f32 v194, v194
    v_rcp_f32 v195, v195
    s_nop 0
    v_pk_mul_f32 v[136:137], v[136:137], v[188:189]
    v_pk_mul_f32 v[138:139], v[138:139], v[190:191]
    v_pk_mul_f32 v[140:141], v[140:141], v[192:193]
    v_pk_mul_f32 v[142:143], v[142:143], v[194:195]
    v_cvt_pk_bf16_f32 v196, v136, v137
    v_cvt_pk_bf16_f32 v197, v138, v139
    v_cvt_pk_bf16_f32 v198, v140, v141
    v_cvt_pk_bf16_f32 v199, v142, v143
    s_nop 1
    v_permlane16_swap_b32 v196, v198
    v_permlane16_swap_b32 v197, v199
    buffer_store_dwordx4 v[196:199], v22, s[36:39], s22 offen offset:1024 sc1
    s_mul_i32 s55, s55, 0x9e3779b1
    s_add_u32 s55, s55, 0x7f4a7c15
    s_mul_i32 s54, s54, 0x9e3779b1
    s_add_u32 s54, s54, 0x7f4a7c15
    s_waitcnt vmcnt(0)
    s_atomic_swap s55, s[16:17], s23
    s_barrier
    s_cmp_lg_u32 s3, 4
    s_cbranch_scc1 L_fin
    s_and_b32 s58, s50, 1
    s_lshl_b32 s58, s58, 3
    s_add_u32 s58, s58, s51
    s_lshr_b32 s59, s50, 1
    s_lshl_b32 s59, s59, 4
    s_add_u32 s59, s59, s58
    s_lshl_b32 s59, s59, 7
    s_add_u32 s59, s59, 3729408
    s_atomic_swap s54, s[16:17], s59
    s_cmp_lg_u32 s58, 0
    s_cbranch_scc1 L_fin
    s_setprio 0
    s_add_u32 s18, s16, s59
    s_addc_u32 s19, s17, 0
    s_mov_b32 s57, 0
L_mark_loop:
    s_sleep 12
    s_load_dword s24, s[18:19], 0 glc
    s_load_dword s25, s[18:19], 128 glc
    s_load_dword s26, s[18:19], 256 glc
    s_load_dword s27, s[18:19], 384 glc
    s_load_dword s28, s[18:19], 512 glc
    s_load_dword s29, s[18:19], 640 glc
    s_load_dword s30, s[18:19], 768 glc
    s_load_dword s31, s[18:19], 896 glc
    s_load_dword s32, s[18:19], 1024 glc
    s_load_dword s33, s[18:19], 1152 glc
    s_load_dword s34, s[18:19], 1280 glc
    s_load_dword s35, s[18:19], 1408 glc
    s_load_dword s36, s[18:19], 1536 glc
    s_load_dword s37, s[18:19], 1664 glc
    s_load_dword s38, s[18:19], 1792 glc
    s_load_dword s39, s[18:19], 1920 glc
    s_add_u32 s57, s57, 1
    s_mov_b32 s56, 0
    s_waitcnt lgkmcnt(0)
    s_xor_b32 s24, s24, s54
    s_or_b32 s56, s56, s24
    s_xor_b32 s25, s25, s54
    s_or_b32 s56, s56, s25
    s_xor_b32 s26, s26, s54
    s_or_b32 s56, s56, s26
    s_xor_b32 s27, s27, s54
    s_or_b32 s56, s56, s27
    s_xor_b32 s28, s28, s54
    s_or_b32 s56, s56, s28
    s_xor_b32 s29, s29, s54
    s_or_b32 s56, s56, s29
    s_xor_b32 s30, s30, s54
    s_or_b32 s56, s56, s30
    s_xor_b32 s31, s31, s54
    s_or_b32 s56, s56, s31
    s_xor_b32 s32, s32, s54
    s_or_b32 s56, s56, s32
    s_xor_b32 s33, s33, s54
    s_or_b32 s56, s56, s33
    s_xor_b32 s34, s34, s54
    s_or_b32 s56, s56, s34
    s_xor_b32 s35, s35, s54
    s_or_b32 s56, s56, s35
    s_xor_b32 s36, s36, s54
    s_or_b32 s56, s56, s36
    s_xor_b32 s37, s37, s54
    s_or_b32 s56, s56, s37
    s_xor_b32 s38, s38, s54
    s_or_b32 s56, s56, s38
    s_xor_b32 s39, s39, s54
    s_or_b32 s56, s56, s39
    s_cmp_ge_u32 s57, 0x40000
    s_cbranch_scc1 L_mark_done
    s_cmp_lg_u32 s56, 0
    s_cbranch_scc1 L_mark_loop
L_mark_done:
    s_lshr_b32 s56, s50, 1
    s_lshl_b32 s56, s56, 7
    s_add_u32 s56, s56, 3727360
    s_barrier
    s_atomic_swap s54, s[16:17], s56
    s_endpgm
L_nop1_compute:
    s_cmp_lg_u32 s3, 4
    s_cbranch_scc1 L_fin
    s_waitcnt lgkmcnt(0)
    s_mul_i32 s54, s54, 0x9e3779b1
    s_add_u32 s54, s54, 0x7f4a7c15
    s_barrier
    s_and_b32 s58, s50, 1
    s_lshl_b32 s58, s58, 3
    s_add_u32 s58, s58, s51
    s_lshr_b32 s59, s50, 1
    s_lshl_b32 s59, s59, 4
    s_add_u32 s59, s59, s58
    s_lshl_b32 s59, s59, 7
    s_add_u32 s59, s59, 3729408
    s_atomic_swap s54, s[16:17], s59
L_fin:
L_end:
    s_endpgm
.section .rodata,"a"
.p2align 6
.amdhsa_kernel standalone__swiglu_ffn__sampling_kernel
  .amdhsa_next_free_vgpr 256
  .amdhsa_next_free_sgpr 64
  .amdhsa_accum_offset 256
  .amdhsa_group_segment_fixed_size 0
  .amdhsa_kernarg_size 56
  .amdhsa_user_sgpr_count 2
  .amdhsa_user_sgpr_kernarg_segment_ptr 1
  .amdhsa_system_sgpr_workgroup_id_x 1
.end_amdhsa_kernel
```
